```python
import torch

def _softmax(x, axis=-1):
    return torch.softmax(x, dim=axis)
def _gelu(x):
    return torch.nn.functional.gelu(x, approximate="tanh")
def _silu(x):
    return torch.nn.functional.silu(x)
def _sigmoid(x):
    return torch.sigmoid(x)
def _layernorm(x, axis=-1, eps=1e-5):
    m = x.mean(dim=axis, keepdim=True)
    v = x.var(dim=axis, keepdim=True, unbiased=False)
    return (x - m) / torch.sqrt(v + eps)
def _scatter_add(tgt, idx, src, axis=0):
    return tgt.clone().index_add_(axis, idx, src)
def _segment_sum(src, seg, n):
    out = torch.zeros((n,) + src.shape[1:], dtype=src.dtype)
    return out.index_add_(0, seg, src)
def _pad(x, pw):
    flat = tuple(v for pair in reversed(pw) for v in pair)
    return torch.nn.functional.pad(x, flat)

kernel_name = 'gated_mix__mha_block_cached__geglu_ffn__decode'

def setup_inputs():

    _w = (lambda a: (lambda t: t.to(torch.bfloat16) if t.is_floating_point() else t)(torch.as_tensor(a)))
    def _A_setup():
        B, Sq, D = 4, 1, 512
        H, Sk, Dh = 32, 8192, 128
        return {
            "x": _w((lambda *s: torch.randn(*s, dtype=torch.bfloat16) * 0.05)(B, Sq, D)),
            "k_cache": _w((lambda *s: torch.randn(*s, dtype=torch.bfloat16) * 6.4)(B, H, Sk, Dh)),
            "v_cache": _w((lambda *s: torch.randn(*s, dtype=torch.bfloat16) * 0.2)(B, H, Sk, Dh)),
            "wq": _w((lambda *s: torch.randn(*s, dtype=torch.bfloat16) * 6.4)(D, H * Dh) * (D ** -0.5)),
            "wo": _w((lambda *s: torch.randn(*s, dtype=torch.bfloat16) * 0.2)(H * Dh, D) * ((H * Dh) ** -0.5)),
        }
    _A_in = _A_setup()

    def _B_setup():
        B, S, D, F = 4, 1, 512, 1792
        return {
            "x": _w((lambda *s: torch.randn(*s, dtype=torch.bfloat16) * 0.05)(B, S, D)),
            "w_gate": _w((lambda *s: torch.randn(*s, dtype=torch.bfloat16) * 0.05)(D, F)),
            "w_up": _w((lambda *s: torch.randn(*s, dtype=torch.bfloat16) * 0.05)(D, F)),
            "w_down": _w((lambda *s: torch.randn(*s, dtype=torch.bfloat16) * 0.05)(F, D)),
        }
    _B_in = _B_setup()

    return {
        "A_x": _A_in["x"],
        "A_k_cache": _A_in["k_cache"],
        "A_v_cache": _A_in["v_cache"],
        "A_wq": _A_in["wq"],
        "A_wo": _A_in["wo"],
        "B_x": _B_in["x"],
        "B_w_gate": _B_in["w_gate"],
        "B_w_up": _B_in["w_up"],
        "B_w_down": _B_in["w_down"],
        "gate_w": _w((lambda *s: torch.randn(*s, dtype=torch.bfloat16) * 0.05)(512) * 16.0),
    }

def reference(A_x, A_k_cache, A_v_cache, A_wq, A_wo, B_x, B_w_gate, B_w_up, B_w_down, gate_w):
    def _A_ref(x, k_cache, v_cache, wq, wo):
        B, Sq, D = x.shape
        H, Dh = 32, 128
        q = (lambda x, *d: x.permute(*d))((x @ wq).reshape(B, Sq, H, Dh), 0, 2, 1, 3)
        scores = torch.einsum("bhqd,bhkd->bhqk", q, k_cache) * (Dh ** -0.5)
        p = _softmax(scores, axis=-1)
        o = torch.einsum("bhqk,bhkd->bhqd", p, v_cache)
        return (lambda x, *d: x.permute(*d))(o, 0, 2, 1, 3).reshape(B, Sq, H * Dh) @ wo

    def _B_ref(x, w_gate, w_up, w_down):
        return (_gelu(x @ w_gate) * (x @ w_up)) @ w_down

    x = A_x
    g = _sigmoid((x * gate_w).sum(-1, keepdims=True))
    a = _A_ref(x, A_k_cache, A_v_cache, A_wq, A_wo)
    b = _B_ref(x, B_w_gate, B_w_up, B_w_down)
    return g * a + (1 - g) * b
```

```asm
; @launch grid=(480,1,1) block=(256,1,1) lds=49152
.amdgcn_target "amdgcn-amd-amdhsa--gfx950"
.text
.globl gated_mix__mha_block_cached__geglu_ffn__decode_kernel
.p2align 8
.type gated_mix__mha_block_cached__geglu_ffn__decode_kernel,@function
gated_mix__mha_block_cached__geglu_ffn__decode_kernel:
    s_cmp_ge_u32 s2, 480
    s_cbranch_scc1 L_end
    s_load_dwordx16 s[16:31], s[0:1], 0
    s_load_dwordx8 s[32:39], s[0:1], 64
    s_load_dwordx2 s[40:41], s[0:1], 96
    v_and_b32 v1, 63, v0
    v_lshrrev_b32 v40, 6, v0
    v_and_b32 v43, 15, v1
    v_readfirstlane_b32 s3, v40
    v_lshlrev_b32 v43, 4, v43
    v_lshrrev_b32 v44, 4, v1
    s_cmp_ge_u32 s2, 256
    s_cbranch_scc1 L_ffn
    s_and_b32 s14, s2, 7
    s_lshr_b32 s15, s2, 3
    s_lshr_b32 s4, s2, 6
    s_lshl_b32 s14, s14, 2
    s_add_u32 s4, s4, s14
    s_and_b32 s42, s15, 7
    s_lshl_b32 s42, s42, 2
    s_lshl_b32 s14, s3, 20
    v_lshlrev_b32 v48, 17, v44
    s_lshl_b32 s94, s4, 8
    v_add3_u32 v48, v48, v43, s14
    s_sub_u32 s54, 4194304, s94
    s_mov_b32 s55, 0x20000
    s_and_b32 s14, s42, 16
    s_mul_i32 s14, s14, 3
    s_add_u32 s7, s42, s14
    s_lshl_b32 s7, s7, 13
    s_waitcnt lgkmcnt(0)
    s_add_u32 s52, s22, s94
    s_addc_u32 s53, s23, 0
    s_and_b32 s53, s53, 0xffff
    buffer_load_dwordx4 v[128:131], v48, s[52:55], s7 offen
    s_add_u32 s7, s7, 8192
    buffer_load_dwordx4 v[132:135], v48, s[52:55], s7 offen
    s_add_u32 s7, s7, 8192
    buffer_load_dwordx4 v[136:139], v48, s[52:55], s7 offen
    s_add_u32 s7, s7, 8192
    buffer_load_dwordx4 v[140:143], v48, s[52:55], s7 offen
    s_lshr_b32 s5, s15, 1
    s_and_b32 s5, s5, 3
    s_and_b32 s15, s15, 1
    s_lshl_b32 s6, s5, 5
    s_add_u32 s6, s6, s4
    s_lshl_b32 s6, s6, 1
    s_add_u32 s6, s6, s15
    s_lshl_b32 s92, s3, 8
    s_lshl_b32 s15, s5, 10
    s_add_u32 s92, s92, s15
    v_and_b32 v40, 15, v1
    v_add_u32 v40, s42, v40
    v_and_b32 v40, 31, v40
    v_xor_b32 v41, 16, v40
    v_and_b32 v45, 16, v40
    v_and_b32 v46, 16, v41
    v_mul_u32_u24 v45, 3, v45
    v_mul_u32_u24 v46, 3, v46
    v_add_u32 v40, v40, v45
    v_add_u32 v41, v41, v46
    v_lshl_add_u32 v40, v44, 4, v40
    v_lshl_add_u32 v41, v44, 4, v41
    v_lshl_add_u32 v40, v40, 1, s92
    v_lshl_add_u32 v41, v41, 1, s92
    s_mov_b32 s56, s16
    s_and_b32 s57, s17, 0xffff
    s_mov_b32 s58, 4096
    s_mov_b32 s59, 0x20000
    buffer_load_ushort v50, v40, s[56:59], 0 offen
    buffer_load_ushort v51, v41, s[56:59], 0 offen
    s_load_dwordx2 s[90:91], s[40:41], 0x90000
    s_add_u32 s7, s42, 4
    s_and_b32 s7, s7, 31
    s_and_b32 s14, s7, 16
    s_mul_i32 s14, s14, 3
    s_add_u32 s7, s7, s14
    s_lshl_b32 s7, s7, 13
    buffer_load_dwordx4 v[144:147], v48, s[52:55], s7 offen
    s_add_u32 s7, s7, 8192
    buffer_load_dwordx4 v[148:151], v48, s[52:55], s7 offen
    s_add_u32 s7, s7, 8192
    buffer_load_dwordx4 v[152:155], v48, s[52:55], s7 offen
    s_add_u32 s7, s7, 8192
    buffer_load_dwordx4 v[156:159], v48, s[52:55], s7 offen
    s_add_u32 s7, s42, 8
    s_and_b32 s7, s7, 31
    s_and_b32 s14, s7, 16
    s_mul_i32 s14, s14, 3
    s_add_u32 s7, s7, s14
    s_lshl_b32 s7, s7, 13
    buffer_load_dwordx4 v[160:163], v48, s[52:55], s7 offen
    s_add_u32 s7, s7, 8192
    buffer_load_dwordx4 v[164:167], v48, s[52:55], s7 offen
    s_add_u32 s7, s7, 8192
    buffer_load_dwordx4 v[168:171], v48, s[52:55], s7 offen
    s_add_u32 s7, s7, 8192
    buffer_load_dwordx4 v[172:175], v48, s[52:55], s7 offen
    s_add_u32 s7, s42, 12
    s_and_b32 s7, s7, 31
    s_and_b32 s14, s7, 16
    s_mul_i32 s14, s14, 3
    s_add_u32 s7, s7, s14
    s_lshl_b32 s7, s7, 13
    buffer_load_dwordx4 v[176:179], v48, s[52:55], s7 offen
    s_add_u32 s7, s7, 8192
    buffer_load_dwordx4 v[180:183], v48, s[52:55], s7 offen
    s_add_u32 s7, s7, 8192
    buffer_load_dwordx4 v[184:187], v48, s[52:55], s7 offen
    s_add_u32 s7, s7, 8192
    buffer_load_dwordx4 v[188:191], v48, s[52:55], s7 offen
    s_and_b32 s88, s6, 3
    s_mul_i32 s89, s6, 4
    s_lshr_b32 s14, s6, 5
    s_mul_i32 s14, s14, 0
    s_add_u32 s89, s89, s14
    s_mul_i32 s14, s3, 1
    s_add_u32 s89, s89, s14
    s_and_b32 s89, s89, 127
    s_lshl_b32 s89, s89, 13
    s_lshr_b32 s14, s6, 0
    s_and_b32 s14, s14, 1
    s_mov_b32 s95, 32768
    s_cmp_eq_u32 s14, 0
    s_cselect_b32 s95, s95, 0xffff8000
    s_lshl_b32 s14, s6, 11
    s_lshl_b32 s15, s3, 9
    s_add_u32 s14, s14, s15
    v_lshlrev_b32 v54, 3, v1
    v_add_u32 v54, s14, v54
    v_mov_b32 v18, -1
    v_mov_b32 v19, -1
    s_lshl_b32 s14, s6, 3
    s_add_u32 s14, s14, 524288
    v_mov_b32 v55, s14
    s_mov_b32 s60, s40
    s_and_b32 s61, s41, 0xffff
    s_mov_b32 s62, 2097152
    s_mov_b32 s63, 0x20000
    buffer_store_dwordx2 v[18:19], v54, s[60:63], 0 offen sc1
    buffer_store_dwordx2 v[18:19], v55, s[60:63], 0 offen sc1
    s_lshl_b32 s92, s6, 20
    s_lshr_b32 s93, s6, 12
    s_add_u32 s44, s18, s92
    s_addc_u32 s45, s19, s93
    s_and_b32 s45, s45, 0xffff
    s_mov_b32 s46, 1048576
    s_mov_b32 s47, 0x20000
    s_add_u32 s48, s20, s92
    s_addc_u32 s49, s21, s93
    s_and_b32 s49, s49, 0xffff
    s_mov_b32 s50, 1048576
    s_mov_b32 s51, 0x20000
    s_mul_i32 s14, s3, 0
    v_lshlrev_b32 v2, 4, v1
    v_add_u32 v2, s14, v2
    v_add_u32 v3, 4096, v2
    s_lshl_b32 s14, s3, 8
    v_lshlrev_b32 v49, 14, v44
    v_add3_u32 v49, v49, v43, s14
    v_lshlrev_b32 v52, 1, v43
    v_lshl_add_u32 v53, v44, 4, v52
    s_lshl_b32 s15, s3, 9
    v_add_u32 v53, s15, v53
    v_mov_b32 v12, 0
    v_mov_b32 v13, 0
    v_mov_b32 v14, 0
    v_mov_b32 v15, 0
    s_mov_b32 s10, 0x3fb8aa3b
    s_mov_b32 s11, 0x3db504f3
    s_mov_b32 s68, 0xffff0000
    v_and_b32 v45, 1, v1
    v_lshlrev_b32 v45, 4, v45
    v_mov_b32 v46, 0xffff
    v_lshlrev_b32 v46, v45, v46
    v_bfe_u32 v47, v1, 1, 3
    v_cmp_eq_u32 vcc, 0, v47
    s_nop 1
    v_cndmask_b32 v4, 0, v46, vcc
    v_cmp_eq_u32 vcc, 1, v47
    s_nop 1
    v_cndmask_b32 v5, 0, v46, vcc
    v_cmp_eq_u32 vcc, 2, v47
    s_nop 1
    v_cndmask_b32 v6, 0, v46, vcc
    v_cmp_eq_u32 vcc, 3, v47
    s_nop 1
    v_cndmask_b32 v7, 0, v46, vcc
    s_waitcnt vmcnt(14)
    v_lshl_or_b32 v50, v50, 16, v50
    v_lshl_or_b32 v51, v51, 16, v51
    s_nop 0
    v_and_b32_dpp v32, v50, v4 row_newbcast:0 row_mask:0xf bank_mask:0xf
    v_and_b32_dpp v33, v50, v5 row_newbcast:0 row_mask:0xf bank_mask:0xf
    v_and_b32_dpp v34, v50, v6 row_newbcast:0 row_mask:0xf bank_mask:0xf
    v_and_b32_dpp v35, v50, v7 row_newbcast:0 row_mask:0xf bank_mask:0xf
    v_and_b32_dpp v36, v50, v4 row_newbcast:1 row_mask:0xf bank_mask:0xf
    v_and_b32_dpp v37, v50, v5 row_newbcast:1 row_mask:0xf bank_mask:0xf
    v_and_b32_dpp v38, v50, v6 row_newbcast:1 row_mask:0xf bank_mask:0xf
    v_and_b32_dpp v39, v50, v7 row_newbcast:1 row_mask:0xf bank_mask:0xf
    s_add_u32 s7, s42, 16
    s_and_b32 s7, s7, 31
    s_and_b32 s14, s7, 16
    s_mul_i32 s14, s14, 3
    s_add_u32 s7, s7, s14
    s_lshl_b32 s7, s7, 13
    buffer_load_dwordx4 v[192:195], v48, s[52:55], s7 offen
    s_add_u32 s7, s7, 8192
    v_mfma_f32_16x16x32_bf16 v[12:15], v[32:35], v[128:131], v[12:15]
    v_and_b32_dpp v32, v50, v4 row_newbcast:2 row_mask:0xf bank_mask:0xf
    v_and_b32_dpp v33, v50, v5 row_newbcast:2 row_mask:0xf bank_mask:0xf
    v_and_b32_dpp v34, v50, v6 row_newbcast:2 row_mask:0xf bank_mask:0xf
    v_and_b32_dpp v35, v50, v7 row_newbcast:2 row_mask:0xf bank_mask:0xf
    buffer_load_dwordx4 v[196:199], v48, s[52:55], s7 offen
    s_add_u32 s7, s7, 8192
    v_mfma_f32_16x16x32_bf16 v[12:15], v[36:39], v[132:135], v[12:15]
    v_and_b32_dpp v36, v50, v4 row_newbcast:3 row_mask:0xf bank_mask:0xf
    v_and_b32_dpp v37, v50, v5 row_newbcast:3 row_mask:0xf bank_mask:0xf
    v_and_b32_dpp v38, v50, v6 row_newbcast:3 row_mask:0xf bank_mask:0xf
    v_and_b32_dpp v39, v50, v7 row_newbcast:3 row_mask:0xf bank_mask:0xf
    buffer_load_dwordx4 v[200:203], v48, s[52:55], s7 offen
    s_add_u32 s7, s7, 8192
    v_mfma_f32_16x16x32_bf16 v[12:15], v[32:35], v[136:139], v[12:15]
    v_and_b32_dpp v32, v50, v4 row_newbcast:4 row_mask:0xf bank_mask:0xf
    v_and_b32_dpp v33, v50, v5 row_newbcast:4 row_mask:0xf bank_mask:0xf
    v_and_b32_dpp v34, v50, v6 row_newbcast:4 row_mask:0xf bank_mask:0xf
    v_and_b32_dpp v35, v50, v7 row_newbcast:4 row_mask:0xf bank_mask:0xf
    buffer_load_dwordx4 v[204:207], v48, s[52:55], s7 offen
    v_mfma_f32_16x16x32_bf16 v[12:15], v[36:39], v[140:143], v[12:15]
    v_and_b32_dpp v36, v50, v4 row_newbcast:5 row_mask:0xf bank_mask:0xf
    v_and_b32_dpp v37, v50, v5 row_newbcast:5 row_mask:0xf bank_mask:0xf
    v_and_b32_dpp v38, v50, v6 row_newbcast:5 row_mask:0xf bank_mask:0xf
    v_and_b32_dpp v39, v50, v7 row_newbcast:5 row_mask:0xf bank_mask:0xf
    s_add_u32 s7, s42, 20
    s_and_b32 s7, s7, 31
    s_and_b32 s14, s7, 16
    s_mul_i32 s14, s14, 3
    s_add_u32 s7, s7, s14
    s_lshl_b32 s7, s7, 13
    buffer_load_dwordx4 v[208:211], v48, s[52:55], s7 offen
    s_add_u32 s7, s7, 8192
    s_waitcnt vmcnt(18)
    v_mfma_f32_16x16x32_bf16 v[12:15], v[32:35], v[144:147], v[12:15]
    v_and_b32_dpp v32, v50, v4 row_newbcast:6 row_mask:0xf bank_mask:0xf
    v_and_b32_dpp v33, v50, v5 row_newbcast:6 row_mask:0xf bank_mask:0xf
    v_and_b32_dpp v34, v50, v6 row_newbcast:6 row_mask:0xf bank_mask:0xf
    v_and_b32_dpp v35, v50, v7 row_newbcast:6 row_mask:0xf bank_mask:0xf
    buffer_load_dwordx4 v[212:215], v48, s[52:55], s7 offen
    s_add_u32 s7, s7, 8192
    s_waitcnt vmcnt(18)
    v_mfma_f32_16x16x32_bf16 v[12:15], v[36:39], v[148:151], v[12:15]
    v_and_b32_dpp v36, v50, v4 row_newbcast:7 row_mask:0xf bank_mask:0xf
    v_and_b32_dpp v37, v50, v5 row_newbcast:7 row_mask:0xf bank_mask:0xf
    v_and_b32_dpp v38, v50, v6 row_newbcast:7 row_mask:0xf bank_mask:0xf
    v_and_b32_dpp v39, v50, v7 row_newbcast:7 row_mask:0xf bank_mask:0xf
    buffer_load_dwordx4 v[216:219], v48, s[52:55], s7 offen
    s_add_u32 s7, s7, 8192
    s_waitcnt vmcnt(18)
    v_mfma_f32_16x16x32_bf16 v[12:15], v[32:35], v[152:155], v[12:15]
    v_and_b32_dpp v32, v50, v4 row_newbcast:8 row_mask:0xf bank_mask:0xf
    v_and_b32_dpp v33, v50, v5 row_newbcast:8 row_mask:0xf bank_mask:0xf
    v_and_b32_dpp v34, v50, v6 row_newbcast:8 row_mask:0xf bank_mask:0xf
    v_and_b32_dpp v35, v50, v7 row_newbcast:8 row_mask:0xf bank_mask:0xf
    buffer_load_dwordx4 v[220:223], v48, s[52:55], s7 offen
    s_waitcnt vmcnt(18)
    v_mfma_f32_16x16x32_bf16 v[12:15], v[36:39], v[156:159], v[12:15]
    v_and_b32_dpp v36, v50, v4 row_newbcast:9 row_mask:0xf bank_mask:0xf
    v_and_b32_dpp v37, v50, v5 row_newbcast:9 row_mask:0xf bank_mask:0xf
    v_and_b32_dpp v38, v50, v6 row_newbcast:9 row_mask:0xf bank_mask:0xf
    v_and_b32_dpp v39, v50, v7 row_newbcast:9 row_mask:0xf bank_mask:0xf
    s_add_u32 s7, s42, 24
    s_and_b32 s7, s7, 31
    s_and_b32 s14, s7, 16
    s_mul_i32 s14, s14, 3
    s_add_u32 s7, s7, s14
    s_lshl_b32 s7, s7, 13
    buffer_load_dwordx4 v[224:227], v48, s[52:55], s7 offen
    s_add_u32 s7, s7, 8192
    s_waitcnt vmcnt(18)
    v_mfma_f32_16x16x32_bf16 v[12:15], v[32:35], v[160:163], v[12:15]
    v_and_b32_dpp v32, v50, v4 row_newbcast:10 row_mask:0xf bank_mask:0xf
    v_and_b32_dpp v33, v50, v5 row_newbcast:10 row_mask:0xf bank_mask:0xf
    v_and_b32_dpp v34, v50, v6 row_newbcast:10 row_mask:0xf bank_mask:0xf
    v_and_b32_dpp v35, v50, v7 row_newbcast:10 row_mask:0xf bank_mask:0xf
    buffer_load_dwordx4 v[228:231], v48, s[52:55], s7 offen
    s_add_u32 s7, s7, 8192
    s_waitcnt vmcnt(18)
    v_mfma_f32_16x16x32_bf16 v[12:15], v[36:39], v[164:167], v[12:15]
    v_and_b32_dpp v36, v50, v4 row_newbcast:11 row_mask:0xf bank_mask:0xf
    v_and_b32_dpp v37, v50, v5 row_newbcast:11 row_mask:0xf bank_mask:0xf
    v_and_b32_dpp v38, v50, v6 row_newbcast:11 row_mask:0xf bank_mask:0xf
    v_and_b32_dpp v39, v50, v7 row_newbcast:11 row_mask:0xf bank_mask:0xf
    buffer_load_dwordx4 v[232:235], v48, s[52:55], s7 offen
    s_add_u32 s7, s7, 8192
    s_waitcnt vmcnt(18)
    v_mfma_f32_16x16x32_bf16 v[12:15], v[32:35], v[168:171], v[12:15]
    v_and_b32_dpp v32, v50, v4 row_newbcast:12 row_mask:0xf bank_mask:0xf
    v_and_b32_dpp v33, v50, v5 row_newbcast:12 row_mask:0xf bank_mask:0xf
    v_and_b32_dpp v34, v50, v6 row_newbcast:12 row_mask:0xf bank_mask:0xf
    v_and_b32_dpp v35, v50, v7 row_newbcast:12 row_mask:0xf bank_mask:0xf
    buffer_load_dwordx4 v[236:239], v48, s[52:55], s7 offen
    s_waitcnt vmcnt(18)
    v_mfma_f32_16x16x32_bf16 v[12:15], v[36:39], v[172:175], v[12:15]
    v_and_b32_dpp v36, v50, v4 row_newbcast:13 row_mask:0xf bank_mask:0xf
    v_and_b32_dpp v37, v50, v5 row_newbcast:13 row_mask:0xf bank_mask:0xf
    v_and_b32_dpp v38, v50, v6 row_newbcast:13 row_mask:0xf bank_mask:0xf
    v_and_b32_dpp v39, v50, v7 row_newbcast:13 row_mask:0xf bank_mask:0xf
    s_add_u32 s7, s42, 28
    s_and_b32 s7, s7, 31
    s_and_b32 s14, s7, 16
    s_mul_i32 s14, s14, 3
    s_add_u32 s7, s7, s14
    s_lshl_b32 s7, s7, 13
    buffer_load_dwordx4 v[240:243], v48, s[52:55], s7 offen
    s_add_u32 s7, s7, 8192
    s_waitcnt vmcnt(18)
    v_mfma_f32_16x16x32_bf16 v[12:15], v[32:35], v[176:179], v[12:15]
    v_and_b32_dpp v32, v50, v4 row_newbcast:14 row_mask:0xf bank_mask:0xf
    v_and_b32_dpp v33, v50, v5 row_newbcast:14 row_mask:0xf bank_mask:0xf
    v_and_b32_dpp v34, v50, v6 row_newbcast:14 row_mask:0xf bank_mask:0xf
    v_and_b32_dpp v35, v50, v7 row_newbcast:14 row_mask:0xf bank_mask:0xf
    buffer_load_dwordx4 v[244:247], v48, s[52:55], s7 offen
    s_add_u32 s7, s7, 8192
    s_waitcnt vmcnt(18)
    v_mfma_f32_16x16x32_bf16 v[12:15], v[36:39], v[180:183], v[12:15]
    v_and_b32_dpp v36, v50, v4 row_newbcast:15 row_mask:0xf bank_mask:0xf
    v_and_b32_dpp v37, v50, v5 row_newbcast:15 row_mask:0xf bank_mask:0xf
    v_and_b32_dpp v38, v50, v6 row_newbcast:15 row_mask:0xf bank_mask:0xf
    v_and_b32_dpp v39, v50, v7 row_newbcast:15 row_mask:0xf bank_mask:0xf
    buffer_load_dwordx4 v[248:251], v48, s[52:55], s7 offen
    s_add_u32 s7, s7, 8192
    s_waitcnt vmcnt(18)
    v_mfma_f32_16x16x32_bf16 v[12:15], v[32:35], v[184:187], v[12:15]
    v_and_b32_dpp v32, v51, v4 row_newbcast:0 row_mask:0xf bank_mask:0xf
    v_and_b32_dpp v33, v51, v5 row_newbcast:0 row_mask:0xf bank_mask:0xf
    v_and_b32_dpp v34, v51, v6 row_newbcast:0 row_mask:0xf bank_mask:0xf
    v_and_b32_dpp v35, v51, v7 row_newbcast:0 row_mask:0xf bank_mask:0xf
    buffer_load_dwordx4 v[252:255], v48, s[52:55], s7 offen
    s_waitcnt vmcnt(18)
    v_mfma_f32_16x16x32_bf16 v[12:15], v[36:39], v[188:191], v[12:15]
    v_and_b32_dpp v36, v51, v4 row_newbcast:1 row_mask:0xf bank_mask:0xf
    v_and_b32_dpp v37, v51, v5 row_newbcast:1 row_mask:0xf bank_mask:0xf
    v_and_b32_dpp v38, v51, v6 row_newbcast:1 row_mask:0xf bank_mask:0xf
    v_and_b32_dpp v39, v51, v7 row_newbcast:1 row_mask:0xf bank_mask:0xf
    s_add_u32 s8, s89, 0
    s_and_b32 s8, s8, 0xfffff
    buffer_load_dwordx4 v[64:67], v2, s[44:47], s8 offen offset:0 nt
    s_waitcnt vmcnt(16)
    v_mfma_f32_16x16x32_bf16 v[12:15], v[32:35], v[192:195], v[12:15]
    v_and_b32_dpp v32, v51, v4 row_newbcast:2 row_mask:0xf bank_mask:0xf
    v_and_b32_dpp v33, v51, v5 row_newbcast:2 row_mask:0xf bank_mask:0xf
    v_and_b32_dpp v34, v51, v6 row_newbcast:2 row_mask:0xf bank_mask:0xf
    v_and_b32_dpp v35, v51, v7 row_newbcast:2 row_mask:0xf bank_mask:0xf
    buffer_load_dwordx4 v[68:71], v2, s[44:47], s8 offen offset:1024 nt
    s_waitcnt vmcnt(16)
    v_mfma_f32_16x16x32_bf16 v[12:15], v[36:39], v[196:199], v[12:15]
    v_and_b32_dpp v36, v51, v4 row_newbcast:3 row_mask:0xf bank_mask:0xf
    v_and_b32_dpp v37, v51, v5 row_newbcast:3 row_mask:0xf bank_mask:0xf
    v_and_b32_dpp v38, v51, v6 row_newbcast:3 row_mask:0xf bank_mask:0xf
    v_and_b32_dpp v39, v51, v7 row_newbcast:3 row_mask:0xf bank_mask:0xf
    buffer_load_dwordx4 v[72:75], v2, s[44:47], s8 offen offset:2048 nt
    s_waitcnt vmcnt(16)
    v_mfma_f32_16x16x32_bf16 v[12:15], v[32:35], v[200:203], v[12:15]
    v_and_b32_dpp v32, v51, v4 row_newbcast:4 row_mask:0xf bank_mask:0xf
    v_and_b32_dpp v33, v51, v5 row_newbcast:4 row_mask:0xf bank_mask:0xf
    v_and_b32_dpp v34, v51, v6 row_newbcast:4 row_mask:0xf bank_mask:0xf
    v_and_b32_dpp v35, v51, v7 row_newbcast:4 row_mask:0xf bank_mask:0xf
    buffer_load_dwordx4 v[76:79], v2, s[44:47], s8 offen offset:3072 nt
    s_waitcnt vmcnt(16)
    v_mfma_f32_16x16x32_bf16 v[12:15], v[36:39], v[204:207], v[12:15]
    v_and_b32_dpp v36, v51, v4 row_newbcast:5 row_mask:0xf bank_mask:0xf
    v_and_b32_dpp v37, v51, v5 row_newbcast:5 row_mask:0xf bank_mask:0xf
    v_and_b32_dpp v38, v51, v6 row_newbcast:5 row_mask:0xf bank_mask:0xf
    v_and_b32_dpp v39, v51, v7 row_newbcast:5 row_mask:0xf bank_mask:0xf
    buffer_load_dwordx4 v[80:83], v3, s[44:47], s8 offen offset:0 nt
    s_waitcnt vmcnt(16)
    v_mfma_f32_16x16x32_bf16 v[12:15], v[32:35], v[208:211], v[12:15]
    v_and_b32_dpp v32, v51, v4 row_newbcast:6 row_mask:0xf bank_mask:0xf
    v_and_b32_dpp v33, v51, v5 row_newbcast:6 row_mask:0xf bank_mask:0xf
    v_and_b32_dpp v34, v51, v6 row_newbcast:6 row_mask:0xf bank_mask:0xf
    v_and_b32_dpp v35, v51, v7 row_newbcast:6 row_mask:0xf bank_mask:0xf
    buffer_load_dwordx4 v[84:87], v3, s[44:47], s8 offen offset:1024 nt
    s_waitcnt vmcnt(16)
    v_mfma_f32_16x16x32_bf16 v[12:15], v[36:39], v[212:215], v[12:15]
    v_and_b32_dpp v36, v51, v4 row_newbcast:7 row_mask:0xf bank_mask:0xf
    v_and_b32_dpp v37, v51, v5 row_newbcast:7 row_mask:0xf bank_mask:0xf
    v_and_b32_dpp v38, v51, v6 row_newbcast:7 row_mask:0xf bank_mask:0xf
    v_and_b32_dpp v39, v51, v7 row_newbcast:7 row_mask:0xf bank_mask:0xf
    buffer_load_dwordx4 v[88:91], v3, s[44:47], s8 offen offset:2048 nt
    s_waitcnt vmcnt(16)
    v_mfma_f32_16x16x32_bf16 v[12:15], v[32:35], v[216:219], v[12:15]
    v_and_b32_dpp v32, v51, v4 row_newbcast:8 row_mask:0xf bank_mask:0xf
    v_and_b32_dpp v33, v51, v5 row_newbcast:8 row_mask:0xf bank_mask:0xf
    v_and_b32_dpp v34, v51, v6 row_newbcast:8 row_mask:0xf bank_mask:0xf
    v_and_b32_dpp v35, v51, v7 row_newbcast:8 row_mask:0xf bank_mask:0xf
    buffer_load_dwordx4 v[92:95], v3, s[44:47], s8 offen offset:3072 nt
    s_waitcnt vmcnt(16)
    v_mfma_f32_16x16x32_bf16 v[12:15], v[36:39], v[220:223], v[12:15]
    v_and_b32_dpp v36, v51, v4 row_newbcast:9 row_mask:0xf bank_mask:0xf
    v_and_b32_dpp v37, v51, v5 row_newbcast:9 row_mask:0xf bank_mask:0xf
    v_and_b32_dpp v38, v51, v6 row_newbcast:9 row_mask:0xf bank_mask:0xf
    v_and_b32_dpp v39, v51, v7 row_newbcast:9 row_mask:0xf bank_mask:0xf
    s_add_u32 s8, s89, 32768
    s_and_b32 s8, s8, 0xfffff
    buffer_load_dwordx4 v[96:99], v2, s[44:47], s8 offen offset:0 nt
    s_waitcnt vmcnt(16)
    v_mfma_f32_16x16x32_bf16 v[12:15], v[32:35], v[224:227], v[12:15]
    v_and_b32_dpp v32, v51, v4 row_newbcast:10 row_mask:0xf bank_mask:0xf
    v_and_b32_dpp v33, v51, v5 row_newbcast:10 row_mask:0xf bank_mask:0xf
    v_and_b32_dpp v34, v51, v6 row_newbcast:10 row_mask:0xf bank_mask:0xf
    v_and_b32_dpp v35, v51, v7 row_newbcast:10 row_mask:0xf bank_mask:0xf
    buffer_load_dwordx4 v[100:103], v2, s[44:47], s8 offen offset:1024 nt
    s_waitcnt vmcnt(16)
    v_mfma_f32_16x16x32_bf16 v[12:15], v[36:39], v[228:231], v[12:15]
    v_and_b32_dpp v36, v51, v4 row_newbcast:11 row_mask:0xf bank_mask:0xf
    v_and_b32_dpp v37, v51, v5 row_newbcast:11 row_mask:0xf bank_mask:0xf
    v_and_b32_dpp v38, v51, v6 row_newbcast:11 row_mask:0xf bank_mask:0xf
    v_and_b32_dpp v39, v51, v7 row_newbcast:11 row_mask:0xf bank_mask:0xf
    buffer_load_dwordx4 v[104:107], v2, s[44:47], s8 offen offset:2048 nt
    s_waitcnt vmcnt(16)
    v_mfma_f32_16x16x32_bf16 v[12:15], v[32:35], v[232:235], v[12:15]
    v_and_b32_dpp v32, v51, v4 row_newbcast:12 row_mask:0xf bank_mask:0xf
    v_and_b32_dpp v33, v51, v5 row_newbcast:12 row_mask:0xf bank_mask:0xf
    v_and_b32_dpp v34, v51, v6 row_newbcast:12 row_mask:0xf bank_mask:0xf
    v_and_b32_dpp v35, v51, v7 row_newbcast:12 row_mask:0xf bank_mask:0xf
    buffer_load_dwordx4 v[108:111], v2, s[44:47], s8 offen offset:3072 nt
    s_waitcnt vmcnt(16)
    v_mfma_f32_16x16x32_bf16 v[12:15], v[36:39], v[236:239], v[12:15]
    v_and_b32_dpp v36, v51, v4 row_newbcast:13 row_mask:0xf bank_mask:0xf
    v_and_b32_dpp v37, v51, v5 row_newbcast:13 row_mask:0xf bank_mask:0xf
    v_and_b32_dpp v38, v51, v6 row_newbcast:13 row_mask:0xf bank_mask:0xf
    v_and_b32_dpp v39, v51, v7 row_newbcast:13 row_mask:0xf bank_mask:0xf
    buffer_load_dwordx4 v[112:115], v3, s[44:47], s8 offen offset:0 nt
    s_waitcnt vmcnt(16)
    v_mfma_f32_16x16x32_bf16 v[12:15], v[32:35], v[240:243], v[12:15]
    v_and_b32_dpp v32, v51, v4 row_newbcast:14 row_mask:0xf bank_mask:0xf
    v_and_b32_dpp v33, v51, v5 row_newbcast:14 row_mask:0xf bank_mask:0xf
    v_and_b32_dpp v34, v51, v6 row_newbcast:14 row_mask:0xf bank_mask:0xf
    v_and_b32_dpp v35, v51, v7 row_newbcast:14 row_mask:0xf bank_mask:0xf
    buffer_load_dwordx4 v[116:119], v3, s[44:47], s8 offen offset:1024 nt
    s_waitcnt vmcnt(16)
    v_mfma_f32_16x16x32_bf16 v[12:15], v[36:39], v[244:247], v[12:15]
    v_and_b32_dpp v36, v51, v4 row_newbcast:15 row_mask:0xf bank_mask:0xf
    v_and_b32_dpp v37, v51, v5 row_newbcast:15 row_mask:0xf bank_mask:0xf
    v_and_b32_dpp v38, v51, v6 row_newbcast:15 row_mask:0xf bank_mask:0xf
    v_and_b32_dpp v39, v51, v7 row_newbcast:15 row_mask:0xf bank_mask:0xf
    buffer_load_dwordx4 v[120:123], v3, s[44:47], s8 offen offset:2048 nt
    s_waitcnt vmcnt(16)
    v_mfma_f32_16x16x32_bf16 v[12:15], v[32:35], v[248:251], v[12:15]
    buffer_load_dwordx4 v[124:127], v3, s[44:47], s8 offen offset:3072 nt
    s_waitcnt vmcnt(16)
    v_mfma_f32_16x16x32_bf16 v[12:15], v[36:39], v[252:255], v[12:15]
    s_mov_b64 exec, 0xffffffff
    s_nop 6
    ds_write_b128 v53, v[12:15]
    s_mov_b64 exec, -1
    s_lshl_b32 s14, s4, 17
    s_sub_u32 s15, 4194304, s14
    s_add_u32 s52, s24, s14
    s_addc_u32 s53, s25, 0
    s_and_b32 s53, s53, 0xffff
    s_mov_b32 s54, s15
    s_mov_b32 s55, 0x20000
    s_waitcnt lgkmcnt(0)
    s_barrier
    ds_read_b128 v[18:21], v52 offset:0
    ds_read_b128 v[22:25], v52 offset:16
    ds_read_b128 v[26:29], v52 offset:512
    ds_read_b128 v[30:33], v52 offset:528
    ds_read_b128 v[34:37], v52 offset:1024
    ds_read_b128 v[38:41], v52 offset:1040
    ds_read_b128 v[56:59], v52 offset:1536
    ds_read_b128 v[60:63], v52 offset:1552
    v_mov_b32 v16, 0xff7fffff
    v_mov_b32 v17, 0
    v_mov_b32 v12, 0
    v_mov_b32 v13, 0
    v_mov_b32 v14, 0
    v_mov_b32 v15, 0
    s_waitcnt lgkmcnt(0)
    s_add_u32 s90, s90, 1
    s_addc_u32 s91, s91, 0
    v_add_f32 v18, v18, v26
    v_add_f32 v34, v34, v56
    v_add_f32 v19, v19, v27
    v_add_f32 v35, v35, v57
    v_add_f32 v20, v20, v28
    v_add_f32 v36, v36, v58
    v_add_f32 v21, v21, v29
    v_add_f32 v37, v37, v59
    v_add_f32 v22, v22, v30
    v_add_f32 v38, v38, v60
    v_add_f32 v23, v23, v31
    v_add_f32 v39, v39, v61
    v_add_f32 v24, v24, v32
    v_add_f32 v40, v40, v62
    v_add_f32 v25, v25, v33
    v_add_f32 v41, v41, v63
    v_add_f32 v18, v18, v34
    v_add_f32 v19, v19, v35
    v_add_f32 v20, v20, v36
    v_add_f32 v21, v21, v37
    v_add_f32 v22, v22, v38
    v_add_f32 v23, v23, v39
    v_add_f32 v24, v24, v40
    v_add_f32 v25, v25, v41
    v_cvt_pk_bf16_f32 v8, v18, v19
    v_cvt_pk_bf16_f32 v9, v20, v21
    v_cvt_pk_bf16_f32 v10, v22, v23
    v_cvt_pk_bf16_f32 v11, v24, v25
    s_lshl_b32 s14, s3, 13
    v_lshlrev_b32 v62, 2, v1
    v_add_u32 v62, s14, v62
    s_waitcnt vmcnt(15)
    v_dot2_f32_bf16 v18, v64, v8, 0
    v_dot2_f32_bf16 v18, v65, v9, v18
    v_dot2_f32_bf16 v18, v66, v10, v18
    v_dot2_f32_bf16 v18, v67, v11, v18
    s_add_u32 s8, s89, 65536
    s_and_b32 s8, s8, 0xfffff
    buffer_load_dwordx4 v[64:67], v2, s[44:47], s8 offen offset:0 nt
    s_waitcnt vmcnt(15)
    v_dot2_f32_bf16 v19, v68, v8, 0
    v_dot2_f32_bf16 v19, v69, v9, v19
    v_dot2_f32_bf16 v19, v70, v10, v19
    v_dot2_f32_bf16 v19, v71, v11, v19
    buffer_load_dwordx4 v[68:71], v2, s[44:47], s8 offen offset:1024 nt
    s_waitcnt vmcnt(15)
    v_dot2_f32_bf16 v20, v72, v8, 0
    v_dot2_f32_bf16 v20, v73, v9, v20
    v_dot2_f32_bf16 v20, v74, v10, v20
    v_dot2_f32_bf16 v20, v75, v11, v20
    buffer_load_dwordx4 v[72:75], v2, s[44:47], s8 offen offset:2048 nt
    s_waitcnt vmcnt(15)
    v_dot2_f32_bf16 v21, v76, v8, 0
    v_dot2_f32_bf16 v21, v77, v9, v21
    v_dot2_f32_bf16 v21, v78, v10, v21
    v_dot2_f32_bf16 v21, v79, v11, v21
    buffer_load_dwordx4 v[76:79], v2, s[44:47], s8 offen offset:3072 nt
    s_waitcnt vmcnt(15)
    v_dot2_f32_bf16 v22, v80, v8, 0
    v_dot2_f32_bf16 v22, v81, v9, v22
    v_dot2_f32_bf16 v22, v82, v10, v22
    v_dot2_f32_bf16 v22, v83, v11, v22
    buffer_load_dwordx4 v[80:83], v3, s[44:47], s8 offen offset:0 nt
    s_waitcnt vmcnt(15)
    v_dot2_f32_bf16 v23, v84, v8, 0
    v_dot2_f32_bf16 v23, v85, v9, v23
    v_dot2_f32_bf16 v23, v86, v10, v23
    v_dot2_f32_bf16 v23, v87, v11, v23
    buffer_load_dwordx4 v[84:87], v3, s[44:47], s8 offen offset:1024 nt
    s_waitcnt vmcnt(15)
    v_dot2_f32_bf16 v24, v88, v8, 0
    v_dot2_f32_bf16 v24, v89, v9, v24
    v_dot2_f32_bf16 v24, v90, v10, v24
    v_dot2_f32_bf16 v24, v91, v11, v24
    buffer_load_dwordx4 v[88:91], v3, s[44:47], s8 offen offset:2048 nt
    s_waitcnt vmcnt(15)
    v_dot2_f32_bf16 v25, v92, v8, 0
    v_dot2_f32_bf16 v25, v93, v9, v25
    v_dot2_f32_bf16 v25, v94, v10, v25
    v_dot2_f32_bf16 v25, v95, v11, v25
    buffer_load_dwordx4 v[92:95], v3, s[44:47], s8 offen offset:3072 nt
    v_add_f32_dpp v26, v18, v18 row_mirror row_mask:0xf bank_mask:0x3
    v_add_f32_dpp v27, v19, v19 row_mirror row_mask:0xf bank_mask:0x3
    v_add_f32_dpp v28, v20, v20 row_mirror row_mask:0xf bank_mask:0x3
    v_add_f32_dpp v29, v21, v21 row_mirror row_mask:0xf bank_mask:0x3
    v_add_f32_dpp v26, v22, v22 row_mirror row_mask:0xf bank_mask:0xc
    v_add_f32_dpp v27, v23, v23 row_mirror row_mask:0xf bank_mask:0xc
    v_add_f32_dpp v28, v24, v24 row_mirror row_mask:0xf bank_mask:0xc
    v_add_f32_dpp v29, v25, v25 row_mirror row_mask:0xf bank_mask:0xc
    v_add_f32_dpp v30, v26, v26 row_half_mirror row_mask:0xf bank_mask:0x5
    v_add_f32_dpp v31, v27, v27 row_half_mirror row_mask:0xf bank_mask:0x5
    s_nop 0
    v_add_f32_dpp v30, v28, v28 row_half_mirror row_mask:0xf bank_mask:0xa
    v_add_f32_dpp v31, v29, v29 row_half_mirror row_mask:0xf bank_mask:0xa
    s_nop 0
    v_add_f32_dpp v30, v30, v30 quad_perm:[1,0,3,2] row_mask:0xf bank_mask:0xf
    v_add_f32_dpp v31, v31, v31 quad_perm:[1,0,3,2] row_mask:0xf bank_mask:0xf
    s_nop 0
    v_add_f32_dpp v30, v30, v30 quad_perm:[2,3,0,1] row_mask:0xf bank_mask:0xf
    v_add_f32_dpp v31, v31, v31 quad_perm:[2,3,0,1] row_mask:0xf bank_mask:0xf
    v_cvt_pk_bf16_f32 v42, v30, v31
    v_lshlrev_b32 v40, 16, v42
    v_and_b32 v41, s68, v42
    v_mul_f32 v40, s11, v40
    v_mul_f32 v41, s11, v41
    v_cvt_pk_bf16_f32 v42, v40, v41
    v_lshlrev_b32 v40, 16, v42
    v_and_b32 v41, s68, v42
    ds_write_b32 v62, v42 offset:16384
    v_max3_f32 v16, v16, v40, v41
    s_waitcnt vmcnt(15)
    v_dot2_f32_bf16 v18, v96, v8, 0
    v_dot2_f32_bf16 v18, v97, v9, v18
    v_dot2_f32_bf16 v18, v98, v10, v18
    v_dot2_f32_bf16 v18, v99, v11, v18
    s_add_u32 s69, s89, 98304
    s_and_b32 s69, s69, 0xfffff
    buffer_load_dwordx4 v[96:99], v2, s[44:47], s69 offen offset:0 nt
    s_waitcnt vmcnt(15)
    v_dot2_f32_bf16 v19, v100, v8, 0
    v_dot2_f32_bf16 v19, v101, v9, v19
    v_dot2_f32_bf16 v19, v102, v10, v19
    v_dot2_f32_bf16 v19, v103, v11, v19
    buffer_load_dwordx4 v[100:103], v2, s[44:47], s69 offen offset:1024 nt
    s_waitcnt vmcnt(15)
    v_dot2_f32_bf16 v20, v104, v8, 0
    v_dot2_f32_bf16 v20, v105, v9, v20
    v_dot2_f32_bf16 v20, v106, v10, v20
    v_dot2_f32_bf16 v20, v107, v11, v20
    buffer_load_dwordx4 v[104:107], v2, s[44:47], s69 offen offset:2048 nt
    s_waitcnt vmcnt(15)
    v_dot2_f32_bf16 v21, v108, v8, 0
    v_dot2_f32_bf16 v21, v109, v9, v21
    v_dot2_f32_bf16 v21, v110, v10, v21
    v_dot2_f32_bf16 v21, v111, v11, v21
    buffer_load_dwordx4 v[108:111], v2, s[44:47], s69 offen offset:3072 nt
    s_waitcnt vmcnt(15)
    v_dot2_f32_bf16 v22, v112, v8, 0
    v_dot2_f32_bf16 v22, v113, v9, v22
    v_dot2_f32_bf16 v22, v114, v10, v22
    v_dot2_f32_bf16 v22, v115, v11, v22
    buffer_load_dwordx4 v[112:115], v3, s[44:47], s69 offen offset:0 nt
    s_waitcnt vmcnt(15)
    v_dot2_f32_bf16 v23, v116, v8, 0
    v_dot2_f32_bf16 v23, v117, v9, v23
    v_dot2_f32_bf16 v23, v118, v10, v23
    v_dot2_f32_bf16 v23, v119, v11, v23
    buffer_load_dwordx4 v[116:119], v3, s[44:47], s69 offen offset:1024 nt
    s_waitcnt vmcnt(15)
    v_dot2_f32_bf16 v24, v120, v8, 0
    v_dot2_f32_bf16 v24, v121, v9, v24
    v_dot2_f32_bf16 v24, v122, v10, v24
    v_dot2_f32_bf16 v24, v123, v11, v24
    buffer_load_dwordx4 v[120:123], v3, s[44:47], s69 offen offset:2048 nt
    s_waitcnt vmcnt(15)
    v_dot2_f32_bf16 v25, v124, v8, 0
    v_dot2_f32_bf16 v25, v125, v9, v25
    v_dot2_f32_bf16 v25, v126, v10, v25
    v_dot2_f32_bf16 v25, v127, v11, v25
    buffer_load_dwordx4 v[124:127], v3, s[44:47], s69 offen offset:3072 nt
    v_add_f32_dpp v26, v18, v18 row_mirror row_mask:0xf bank_mask:0x3
    v_add_f32_dpp v27, v19, v19 row_mirror row_mask:0xf bank_mask:0x3
    v_add_f32_dpp v28, v20, v20 row_mirror row_mask:0xf bank_mask:0x3
    v_add_f32_dpp v29, v21, v21 row_mirror row_mask:0xf bank_mask:0x3
    v_add_f32_dpp v26, v22, v22 row_mirror row_mask:0xf bank_mask:0xc
    v_add_f32_dpp v27, v23, v23 row_mirror row_mask:0xf bank_mask:0xc
    v_add_f32_dpp v28, v24, v24 row_mirror row_mask:0xf bank_mask:0xc
    v_add_f32_dpp v29, v25, v25 row_mirror row_mask:0xf bank_mask:0xc
    v_add_f32_dpp v30, v26, v26 row_half_mirror row_mask:0xf bank_mask:0x5
    v_add_f32_dpp v31, v27, v27 row_half_mirror row_mask:0xf bank_mask:0x5
    s_nop 0
    v_add_f32_dpp v30, v28, v28 row_half_mirror row_mask:0xf bank_mask:0xa
    v_add_f32_dpp v31, v29, v29 row_half_mirror row_mask:0xf bank_mask:0xa
    s_nop 0
    v_add_f32_dpp v30, v30, v30 quad_perm:[1,0,3,2] row_mask:0xf bank_mask:0xf
    v_add_f32_dpp v31, v31, v31 quad_perm:[1,0,3,2] row_mask:0xf bank_mask:0xf
    s_nop 0
    v_add_f32_dpp v30, v30, v30 quad_perm:[2,3,0,1] row_mask:0xf bank_mask:0xf
    v_add_f32_dpp v31, v31, v31 quad_perm:[2,3,0,1] row_mask:0xf bank_mask:0xf
    v_cvt_pk_bf16_f32 v42, v30, v31
    v_lshlrev_b32 v40, 16, v42
    v_and_b32 v41, s68, v42
    v_mul_f32 v40, s11, v40
    v_mul_f32 v41, s11, v41
    v_cvt_pk_bf16_f32 v42, v40, v41
    v_lshlrev_b32 v40, 16, v42
    v_and_b32 v41, s68, v42
    ds_write_b32 v62, v42 offset:16640
    v_max3_f32 v16, v16, v40, v41
    v_add_u32 v62, 512, v62
    s_waitcnt vmcnt(15)
    v_dot2_f32_bf16 v18, v64, v8, 0
    v_dot2_f32_bf16 v18, v65, v9, v18
    v_dot2_f32_bf16 v18, v66, v10, v18
    v_dot2_f32_bf16 v18, v67, v11, v18
    s_mov_b32 s7, 0
    buffer_load_dwordx4 v[128:131], v49, s[52:55], s7 offen offset:0
    s_waitcnt vmcnt(15)
    v_dot2_f32_bf16 v19, v68, v8, 0
    v_dot2_f32_bf16 v19, v69, v9, v19
    v_dot2_f32_bf16 v19, v70, v10, v19
    v_dot2_f32_bf16 v19, v71, v11, v19
    s_waitcnt vmcnt(14)
    v_dot2_f32_bf16 v20, v72, v8, 0
    v_dot2_f32_bf16 v20, v73, v9, v20
    v_dot2_f32_bf16 v20, v74, v10, v20
    v_dot2_f32_bf16 v20, v75, v11, v20
    buffer_load_dwordx4 v[132:135], v49, s[52:55], s7 offen offset:1024
    s_waitcnt vmcnt(14)
    v_dot2_f32_bf16 v21, v76, v8, 0
    v_dot2_f32_bf16 v21, v77, v9, v21
    v_dot2_f32_bf16 v21, v78, v10, v21
    v_dot2_f32_bf16 v21, v79, v11, v21
    s_waitcnt vmcnt(13)
    v_dot2_f32_bf16 v22, v80, v8, 0
    v_dot2_f32_bf16 v22, v81, v9, v22
    v_dot2_f32_bf16 v22, v82, v10, v22
    v_dot2_f32_bf16 v22, v83, v11, v22
    buffer_load_dwordx4 v[136:139], v49, s[52:55], s7 offen offset:2048
    s_waitcnt vmcnt(13)
    v_dot2_f32_bf16 v23, v84, v8, 0
    v_dot2_f32_bf16 v23, v85, v9, v23
    v_dot2_f32_bf16 v23, v86, v10, v23
    v_dot2_f32_bf16 v23, v87, v11, v23
    s_waitcnt vmcnt(12)
    v_dot2_f32_bf16 v24, v88, v8, 0
    v_dot2_f32_bf16 v24, v89, v9, v24
    v_dot2_f32_bf16 v24, v90, v10, v24
    v_dot2_f32_bf16 v24, v91, v11, v24
    buffer_load_dwordx4 v[140:143], v49, s[52:55], s7 offen offset:3072
    s_waitcnt vmcnt(12)
    v_dot2_f32_bf16 v25, v92, v8, 0
    v_dot2_f32_bf16 v25, v93, v9, v25
    v_dot2_f32_bf16 v25, v94, v10, v25
    v_dot2_f32_bf16 v25, v95, v11, v25
    v_add_f32_dpp v26, v18, v18 row_mirror row_mask:0xf bank_mask:0x3
    v_add_f32_dpp v27, v19, v19 row_mirror row_mask:0xf bank_mask:0x3
    v_add_f32_dpp v28, v20, v20 row_mirror row_mask:0xf bank_mask:0x3
    v_add_f32_dpp v29, v21, v21 row_mirror row_mask:0xf bank_mask:0x3
    v_add_f32_dpp v26, v22, v22 row_mirror row_mask:0xf bank_mask:0xc
    v_add_f32_dpp v27, v23, v23 row_mirror row_mask:0xf bank_mask:0xc
    v_add_f32_dpp v28, v24, v24 row_mirror row_mask:0xf bank_mask:0xc
    v_add_f32_dpp v29, v25, v25 row_mirror row_mask:0xf bank_mask:0xc
    v_add_f32_dpp v30, v26, v26 row_half_mirror row_mask:0xf bank_mask:0x5
    v_add_f32_dpp v31, v27, v27 row_half_mirror row_mask:0xf bank_mask:0x5
    s_nop 0
    v_add_f32_dpp v30, v28, v28 row_half_mirror row_mask:0xf bank_mask:0xa
    v_add_f32_dpp v31, v29, v29 row_half_mirror row_mask:0xf bank_mask:0xa
    s_nop 0
    v_add_f32_dpp v30, v30, v30 quad_perm:[1,0,3,2] row_mask:0xf bank_mask:0xf
    v_add_f32_dpp v31, v31, v31 quad_perm:[1,0,3,2] row_mask:0xf bank_mask:0xf
    s_nop 0
    v_add_f32_dpp v30, v30, v30 quad_perm:[2,3,0,1] row_mask:0xf bank_mask:0xf
    v_add_f32_dpp v31, v31, v31 quad_perm:[2,3,0,1] row_mask:0xf bank_mask:0xf
    v_cvt_pk_bf16_f32 v42, v30, v31
    v_lshlrev_b32 v40, 16, v42
    v_and_b32 v41, s68, v42
    v_mul_f32 v40, s11, v40
    v_mul_f32 v41, s11, v41
    v_cvt_pk_bf16_f32 v42, v40, v41
    v_lshlrev_b32 v40, 16, v42
    v_and_b32 v41, s68, v42
    ds_write_b32 v62, v42 offset:16384
    v_max3_f32 v16, v16, v40, v41
    s_waitcnt vmcnt(11)
    v_dot2_f32_bf16 v18, v96, v8, 0
    v_dot2_f32_bf16 v18, v97, v9, v18
    v_dot2_f32_bf16 v18, v98, v10, v18
    v_dot2_f32_bf16 v18, v99, v11, v18
    s_mov_b32 s7, 4096
    buffer_load_dwordx4 v[144:147], v49, s[52:55], s7 offen offset:0
    s_waitcnt vmcnt(11)
    v_dot2_f32_bf16 v19, v100, v8, 0
    v_dot2_f32_bf16 v19, v101, v9, v19
    v_dot2_f32_bf16 v19, v102, v10, v19
    v_dot2_f32_bf16 v19, v103, v11, v19
    s_waitcnt vmcnt(10)
    v_dot2_f32_bf16 v20, v104, v8, 0
    v_dot2_f32_bf16 v20, v105, v9, v20
    v_dot2_f32_bf16 v20, v106, v10, v20
    v_dot2_f32_bf16 v20, v107, v11, v20
    buffer_load_dwordx4 v[148:151], v49, s[52:55], s7 offen offset:1024
    s_waitcnt vmcnt(10)
    v_dot2_f32_bf16 v21, v108, v8, 0
    v_dot2_f32_bf16 v21, v109, v9, v21
    v_dot2_f32_bf16 v21, v110, v10, v21
    v_dot2_f32_bf16 v21, v111, v11, v21
    s_add_u32 s8, s89, 131072
    s_and_b32 s8, s8, 0xfffff
    buffer_load_dwordx4 v[64:67], v2, s[44:47], s8 offen offset:0 nt
    s_waitcnt vmcnt(10)
    v_dot2_f32_bf16 v22, v112, v8, 0
    v_dot2_f32_bf16 v22, v113, v9, v22
    v_dot2_f32_bf16 v22, v114, v10, v22
    v_dot2_f32_bf16 v22, v115, v11, v22
    buffer_load_dwordx4 v[68:71], v2, s[44:47], s8 offen offset:1024 nt
    buffer_load_dwordx4 v[152:155], v49, s[52:55], s7 offen offset:2048
    s_waitcnt vmcnt(11)
    v_dot2_f32_bf16 v23, v116, v8, 0
    v_dot2_f32_bf16 v23, v117, v9, v23
    v_dot2_f32_bf16 v23, v118, v10, v23
    v_dot2_f32_bf16 v23, v119, v11, v23
    buffer_load_dwordx4 v[72:75], v2, s[44:47], s8 offen offset:2048 nt
    s_waitcnt vmcnt(11)
    v_dot2_f32_bf16 v24, v120, v8, 0
    v_dot2_f32_bf16 v24, v121, v9, v24
    v_dot2_f32_bf16 v24, v122, v10, v24
    v_dot2_f32_bf16 v24, v123, v11, v24
    buffer_load_dwordx4 v[76:79], v2, s[44:47], s8 offen offset:3072 nt
    buffer_load_dwordx4 v[156:159], v49, s[52:55], s7 offen offset:3072
    s_waitcnt vmcnt(12)
    v_dot2_f32_bf16 v25, v124, v8, 0
    v_dot2_f32_bf16 v25, v125, v9, v25
    v_dot2_f32_bf16 v25, v126, v10, v25
    v_dot2_f32_bf16 v25, v127, v11, v25
    buffer_load_dwordx4 v[80:83], v3, s[44:47], s8 offen offset:0 nt
    v_add_f32_dpp v26, v18, v18 row_mirror row_mask:0xf bank_mask:0x3
    v_add_f32_dpp v27, v19, v19 row_mirror row_mask:0xf bank_mask:0x3
    v_add_f32_dpp v28, v20, v20 row_mirror row_mask:0xf bank_mask:0x3
    v_add_f32_dpp v29, v21, v21 row_mirror row_mask:0xf bank_mask:0x3
    v_add_f32_dpp v26, v22, v22 row_mirror row_mask:0xf bank_mask:0xc
    v_add_f32_dpp v27, v23, v23 row_mirror row_mask:0xf bank_mask:0xc
    v_add_f32_dpp v28, v24, v24 row_mirror row_mask:0xf bank_mask:0xc
    v_add_f32_dpp v29, v25, v25 row_mirror row_mask:0xf bank_mask:0xc
    v_add_f32_dpp v30, v26, v26 row_half_mirror row_mask:0xf bank_mask:0x5
    v_add_f32_dpp v31, v27, v27 row_half_mirror row_mask:0xf bank_mask:0x5
    s_nop 0
    v_add_f32_dpp v30, v28, v28 row_half_mirror row_mask:0xf bank_mask:0xa
    v_add_f32_dpp v31, v29, v29 row_half_mirror row_mask:0xf bank_mask:0xa
    s_nop 0
    v_add_f32_dpp v30, v30, v30 quad_perm:[1,0,3,2] row_mask:0xf bank_mask:0xf
    v_add_f32_dpp v31, v31, v31 quad_perm:[1,0,3,2] row_mask:0xf bank_mask:0xf
    s_nop 0
    v_add_f32_dpp v30, v30, v30 quad_perm:[2,3,0,1] row_mask:0xf bank_mask:0xf
    v_add_f32_dpp v31, v31, v31 quad_perm:[2,3,0,1] row_mask:0xf bank_mask:0xf
    v_cvt_pk_bf16_f32 v42, v30, v31
    v_lshlrev_b32 v40, 16, v42
    v_and_b32 v41, s68, v42
    v_mul_f32 v40, s11, v40
    v_mul_f32 v41, s11, v41
    v_cvt_pk_bf16_f32 v42, v40, v41
    v_lshlrev_b32 v40, 16, v42
    v_and_b32 v41, s68, v42
    ds_write_b32 v62, v42 offset:16640
    v_max3_f32 v16, v16, v40, v41
    v_add_u32 v62, 512, v62
    s_waitcnt vmcnt(6)
    v_dot2_f32_bf16 v18, v64, v8, 0
    v_dot2_f32_bf16 v18, v65, v9, v18
    v_dot2_f32_bf16 v18, v66, v10, v18
    v_dot2_f32_bf16 v18, v67, v11, v18
    buffer_load_dwordx4 v[84:87], v3, s[44:47], s8 offen offset:1024 nt
    s_mov_b32 s7, 8192
    buffer_load_dwordx4 v[160:163], v49, s[52:55], s7 offen offset:0
    s_waitcnt vmcnt(7)
    v_dot2_f32_bf16 v19, v68, v8, 0
    v_dot2_f32_bf16 v19, v69, v9, v19
    v_dot2_f32_bf16 v19, v70, v10, v19
    v_dot2_f32_bf16 v19, v71, v11, v19
    buffer_load_dwordx4 v[88:91], v3, s[44:47], s8 offen offset:2048 nt
    s_waitcnt vmcnt(6)
    v_dot2_f32_bf16 v20, v72, v8, 0
    v_dot2_f32_bf16 v20, v73, v9, v20
    v_dot2_f32_bf16 v20, v74, v10, v20
    v_dot2_f32_bf16 v20, v75, v11, v20
    buffer_load_dwordx4 v[92:95], v3, s[44:47], s8 offen offset:3072 nt
    buffer_load_dwordx4 v[164:167], v49, s[52:55], s7 offen offset:1024
    s_waitcnt vmcnt(7)
    v_dot2_f32_bf16 v21, v76, v8, 0
    v_dot2_f32_bf16 v21, v77, v9, v21
    v_dot2_f32_bf16 v21, v78, v10, v21
    v_dot2_f32_bf16 v21, v79, v11, v21
    s_add_u32 s69, s89, 163840
    s_and_b32 s69, s69, 0xfffff
    buffer_load_dwordx4 v[96:99], v2, s[44:47], s69 offen offset:0 nt
    s_waitcnt vmcnt(6)
    v_dot2_f32_bf16 v22, v80, v8, 0
    v_dot2_f32_bf16 v22, v81, v9, v22
    v_dot2_f32_bf16 v22, v82, v10, v22
    v_dot2_f32_bf16 v22, v83, v11, v22
    buffer_load_dwordx4 v[100:103], v2, s[44:47], s69 offen offset:1024 nt
    buffer_load_dwordx4 v[168:171], v49, s[52:55], s7 offen offset:2048
    s_waitcnt vmcnt(7)
    v_dot2_f32_bf16 v23, v84, v8, 0
    v_dot2_f32_bf16 v23, v85, v9, v23
    v_dot2_f32_bf16 v23, v86, v10, v23
    v_dot2_f32_bf16 v23, v87, v11, v23
    buffer_load_dwordx4 v[104:107], v2, s[44:47], s69 offen offset:2048 nt
    s_waitcnt vmcnt(6)
    v_dot2_f32_bf16 v24, v88, v8, 0
    v_dot2_f32_bf16 v24, v89, v9, v24
    v_dot2_f32_bf16 v24, v90, v10, v24
    v_dot2_f32_bf16 v24, v91, v11, v24
    buffer_load_dwordx4 v[108:111], v2, s[44:47], s69 offen offset:3072 nt
    buffer_load_dwordx4 v[172:175], v49, s[52:55], s7 offen offset:3072
    s_waitcnt vmcnt(7)
    v_dot2_f32_bf16 v25, v92, v8, 0
    v_dot2_f32_bf16 v25, v93, v9, v25
    v_dot2_f32_bf16 v25, v94, v10, v25
    v_dot2_f32_bf16 v25, v95, v11, v25
    buffer_load_dwordx4 v[112:115], v3, s[44:47], s69 offen offset:0 nt
    v_add_f32_dpp v26, v18, v18 row_mirror row_mask:0xf bank_mask:0x3
    v_add_f32_dpp v27, v19, v19 row_mirror row_mask:0xf bank_mask:0x3
    v_add_f32_dpp v28, v20, v20 row_mirror row_mask:0xf bank_mask:0x3
    v_add_f32_dpp v29, v21, v21 row_mirror row_mask:0xf bank_mask:0x3
    v_add_f32_dpp v26, v22, v22 row_mirror row_mask:0xf bank_mask:0xc
    v_add_f32_dpp v27, v23, v23 row_mirror row_mask:0xf bank_mask:0xc
    v_add_f32_dpp v28, v24, v24 row_mirror row_mask:0xf bank_mask:0xc
    v_add_f32_dpp v29, v25, v25 row_mirror row_mask:0xf bank_mask:0xc
    v_add_f32_dpp v30, v26, v26 row_half_mirror row_mask:0xf bank_mask:0x5
    v_add_f32_dpp v31, v27, v27 row_half_mirror row_mask:0xf bank_mask:0x5
    s_nop 0
    v_add_f32_dpp v30, v28, v28 row_half_mirror row_mask:0xf bank_mask:0xa
    v_add_f32_dpp v31, v29, v29 row_half_mirror row_mask:0xf bank_mask:0xa
    s_nop 0
    v_add_f32_dpp v30, v30, v30 quad_perm:[1,0,3,2] row_mask:0xf bank_mask:0xf
    v_add_f32_dpp v31, v31, v31 quad_perm:[1,0,3,2] row_mask:0xf bank_mask:0xf
    s_nop 0
    v_add_f32_dpp v30, v30, v30 quad_perm:[2,3,0,1] row_mask:0xf bank_mask:0xf
    v_add_f32_dpp v31, v31, v31 quad_perm:[2,3,0,1] row_mask:0xf bank_mask:0xf
    v_cvt_pk_bf16_f32 v42, v30, v31
    v_lshlrev_b32 v40, 16, v42
    v_and_b32 v41, s68, v42
    v_mul_f32 v40, s11, v40
    v_mul_f32 v41, s11, v41
    v_cvt_pk_bf16_f32 v42, v40, v41
    v_lshlrev_b32 v40, 16, v42
    v_and_b32 v41, s68, v42
    ds_write_b32 v62, v42 offset:16384
    v_max3_f32 v16, v16, v40, v41
    s_waitcnt vmcnt(6)
    v_dot2_f32_bf16 v18, v96, v8, 0
    v_dot2_f32_bf16 v18, v97, v9, v18
    v_dot2_f32_bf16 v18, v98, v10, v18
    v_dot2_f32_bf16 v18, v99, v11, v18
    buffer_load_dwordx4 v[116:119], v3, s[44:47], s69 offen offset:1024 nt
    s_mov_b32 s7, 12288
    buffer_load_dwordx4 v[176:179], v49, s[52:55], s7 offen offset:0
    s_waitcnt vmcnt(7)
    v_dot2_f32_bf16 v19, v100, v8, 0
    v_dot2_f32_bf16 v19, v101, v9, v19
    v_dot2_f32_bf16 v19, v102, v10, v19
    v_dot2_f32_bf16 v19, v103, v11, v19
    buffer_load_dwordx4 v[120:123], v3, s[44:47], s69 offen offset:2048 nt
    s_waitcnt vmcnt(6)
    v_dot2_f32_bf16 v20, v104, v8, 0
    v_dot2_f32_bf16 v20, v105, v9, v20
    v_dot2_f32_bf16 v20, v106, v10, v20
    v_dot2_f32_bf16 v20, v107, v11, v20
    buffer_load_dwordx4 v[124:127], v3, s[44:47], s69 offen offset:3072 nt
    buffer_load_dwordx4 v[180:183], v49, s[52:55], s7 offen offset:1024
    s_waitcnt vmcnt(7)
    v_dot2_f32_bf16 v21, v108, v8, 0
    v_dot2_f32_bf16 v21, v109, v9, v21
    v_dot2_f32_bf16 v21, v110, v10, v21
    v_dot2_f32_bf16 v21, v111, v11, v21
    s_add_u32 s8, s89, 196608
    s_and_b32 s8, s8, 0xfffff
    buffer_load_dwordx4 v[64:67], v2, s[44:47], s8 offen offset:0 nt
    s_waitcnt vmcnt(6)
    v_dot2_f32_bf16 v22, v112, v8, 0
    v_dot2_f32_bf16 v22, v113, v9, v22
    v_dot2_f32_bf16 v22, v114, v10, v22
    v_dot2_f32_bf16 v22, v115, v11, v22
    buffer_load_dwordx4 v[68:71], v2, s[44:47], s8 offen offset:1024 nt
    buffer_load_dwordx4 v[184:187], v49, s[52:55], s7 offen offset:2048
    s_waitcnt vmcnt(7)
    v_dot2_f32_bf16 v23, v116, v8, 0
    v_dot2_f32_bf16 v23, v117, v9, v23
    v_dot2_f32_bf16 v23, v118, v10, v23
    v_dot2_f32_bf16 v23, v119, v11, v23
    buffer_load_dwordx4 v[72:75], v2, s[44:47], s8 offen offset:2048 nt
    s_waitcnt vmcnt(6)
    v_dot2_f32_bf16 v24, v120, v8, 0
    v_dot2_f32_bf16 v24, v121, v9, v24
    v_dot2_f32_bf16 v24, v122, v10, v24
    v_dot2_f32_bf16 v24, v123, v11, v24
    buffer_load_dwordx4 v[76:79], v2, s[44:47], s8 offen offset:3072 nt
    buffer_load_dwordx4 v[188:191], v49, s[52:55], s7 offen offset:3072
    s_waitcnt vmcnt(7)
    v_dot2_f32_bf16 v25, v124, v8, 0
    v_dot2_f32_bf16 v25, v125, v9, v25
    v_dot2_f32_bf16 v25, v126, v10, v25
    v_dot2_f32_bf16 v25, v127, v11, v25
    buffer_load_dwordx4 v[80:83], v3, s[44:47], s8 offen offset:0 nt
    v_add_f32_dpp v26, v18, v18 row_mirror row_mask:0xf bank_mask:0x3
    v_add_f32_dpp v27, v19, v19 row_mirror row_mask:0xf bank_mask:0x3
    v_add_f32_dpp v28, v20, v20 row_mirror row_mask:0xf bank_mask:0x3
    v_add_f32_dpp v29, v21, v21 row_mirror row_mask:0xf bank_mask:0x3
    v_add_f32_dpp v26, v22, v22 row_mirror row_mask:0xf bank_mask:0xc
    v_add_f32_dpp v27, v23, v23 row_mirror row_mask:0xf bank_mask:0xc
    v_add_f32_dpp v28, v24, v24 row_mirror row_mask:0xf bank_mask:0xc
    v_add_f32_dpp v29, v25, v25 row_mirror row_mask:0xf bank_mask:0xc
    v_add_f32_dpp v30, v26, v26 row_half_mirror row_mask:0xf bank_mask:0x5
    v_add_f32_dpp v31, v27, v27 row_half_mirror row_mask:0xf bank_mask:0x5
    s_nop 0
    v_add_f32_dpp v30, v28, v28 row_half_mirror row_mask:0xf bank_mask:0xa
    v_add_f32_dpp v31, v29, v29 row_half_mirror row_mask:0xf bank_mask:0xa
    s_nop 0
    v_add_f32_dpp v30, v30, v30 quad_perm:[1,0,3,2] row_mask:0xf bank_mask:0xf
    v_add_f32_dpp v31, v31, v31 quad_perm:[1,0,3,2] row_mask:0xf bank_mask:0xf
    s_nop 0
    v_add_f32_dpp v30, v30, v30 quad_perm:[2,3,0,1] row_mask:0xf bank_mask:0xf
    v_add_f32_dpp v31, v31, v31 quad_perm:[2,3,0,1] row_mask:0xf bank_mask:0xf
    v_cvt_pk_bf16_f32 v42, v30, v31
    v_lshlrev_b32 v40, 16, v42
    v_and_b32 v41, s68, v42
    v_mul_f32 v40, s11, v40
    v_mul_f32 v41, s11, v41
    v_cvt_pk_bf16_f32 v42, v40, v41
    v_lshlrev_b32 v40, 16, v42
    v_and_b32 v41, s68, v42
    ds_write_b32 v62, v42 offset:16640
    v_max3_f32 v16, v16, v40, v41
    v_add_u32 v62, 512, v62
    s_waitcnt vmcnt(6)
    v_dot2_f32_bf16 v18, v64, v8, 0
    v_dot2_f32_bf16 v18, v65, v9, v18
    v_dot2_f32_bf16 v18, v66, v10, v18
    v_dot2_f32_bf16 v18, v67, v11, v18
    buffer_load_dwordx4 v[84:87], v3, s[44:47], s8 offen offset:1024 nt
    s_mov_b32 s7, 65536
    buffer_load_dwordx4 v[192:195], v49, s[52:55], s7 offen offset:0
    s_waitcnt vmcnt(7)
    v_dot2_f32_bf16 v19, v68, v8, 0
    v_dot2_f32_bf16 v19, v69, v9, v19
    v_dot2_f32_bf16 v19, v70, v10, v19
    v_dot2_f32_bf16 v19, v71, v11, v19
    buffer_load_dwordx4 v[88:91], v3, s[44:47], s8 offen offset:2048 nt
    s_waitcnt vmcnt(6)
    v_dot2_f32_bf16 v20, v72, v8, 0
    v_dot2_f32_bf16 v20, v73, v9, v20
    v_dot2_f32_bf16 v20, v74, v10, v20
    v_dot2_f32_bf16 v20, v75, v11, v20
    buffer_load_dwordx4 v[92:95], v3, s[44:47], s8 offen offset:3072 nt
    buffer_load_dwordx4 v[196:199], v49, s[52:55], s7 offen offset:1024
    s_waitcnt vmcnt(7)
    v_dot2_f32_bf16 v21, v76, v8, 0
    v_dot2_f32_bf16 v21, v77, v9, v21
    v_dot2_f32_bf16 v21, v78, v10, v21
    v_dot2_f32_bf16 v21, v79, v11, v21
    s_add_u32 s69, s89, 229376
    s_and_b32 s69, s69, 0xfffff
    buffer_load_dwordx4 v[96:99], v2, s[44:47], s69 offen offset:0 nt
    s_waitcnt vmcnt(6)
    v_dot2_f32_bf16 v22, v80, v8, 0
    v_dot2_f32_bf16 v22, v81, v9, v22
    v_dot2_f32_bf16 v22, v82, v10, v22
    v_dot2_f32_bf16 v22, v83, v11, v22
    buffer_load_dwordx4 v[100:103], v2, s[44:47], s69 offen offset:1024 nt
    buffer_load_dwordx4 v[200:203], v49, s[52:55], s7 offen offset:2048
    s_waitcnt vmcnt(7)
    v_dot2_f32_bf16 v23, v84, v8, 0
    v_dot2_f32_bf16 v23, v85, v9, v23
    v_dot2_f32_bf16 v23, v86, v10, v23
    v_dot2_f32_bf16 v23, v87, v11, v23
    buffer_load_dwordx4 v[104:107], v2, s[44:47], s69 offen offset:2048 nt
    s_waitcnt vmcnt(6)
    v_dot2_f32_bf16 v24, v88, v8, 0
    v_dot2_f32_bf16 v24, v89, v9, v24
    v_dot2_f32_bf16 v24, v90, v10, v24
    v_dot2_f32_bf16 v24, v91, v11, v24
    buffer_load_dwordx4 v[108:111], v2, s[44:47], s69 offen offset:3072 nt
    buffer_load_dwordx4 v[204:207], v49, s[52:55], s7 offen offset:3072
    s_waitcnt vmcnt(7)
    v_dot2_f32_bf16 v25, v92, v8, 0
    v_dot2_f32_bf16 v25, v93, v9, v25
    v_dot2_f32_bf16 v25, v94, v10, v25
    v_dot2_f32_bf16 v25, v95, v11, v25
    buffer_load_dwordx4 v[112:115], v3, s[44:47], s69 offen offset:0 nt
    v_add_f32_dpp v26, v18, v18 row_mirror row_mask:0xf bank_mask:0x3
    v_add_f32_dpp v27, v19, v19 row_mirror row_mask:0xf bank_mask:0x3
    v_add_f32_dpp v28, v20, v20 row_mirror row_mask:0xf bank_mask:0x3
    v_add_f32_dpp v29, v21, v21 row_mirror row_mask:0xf bank_mask:0x3
    v_add_f32_dpp v26, v22, v22 row_mirror row_mask:0xf bank_mask:0xc
    v_add_f32_dpp v27, v23, v23 row_mirror row_mask:0xf bank_mask:0xc
    v_add_f32_dpp v28, v24, v24 row_mirror row_mask:0xf bank_mask:0xc
    v_add_f32_dpp v29, v25, v25 row_mirror row_mask:0xf bank_mask:0xc
    v_add_f32_dpp v30, v26, v26 row_half_mirror row_mask:0xf bank_mask:0x5
    v_add_f32_dpp v31, v27, v27 row_half_mirror row_mask:0xf bank_mask:0x5
    s_nop 0
    v_add_f32_dpp v30, v28, v28 row_half_mirror row_mask:0xf bank_mask:0xa
    v_add_f32_dpp v31, v29, v29 row_half_mirror row_mask:0xf bank_mask:0xa
    s_nop 0
    v_add_f32_dpp v30, v30, v30 quad_perm:[1,0,3,2] row_mask:0xf bank_mask:0xf
    v_add_f32_dpp v31, v31, v31 quad_perm:[1,0,3,2] row_mask:0xf bank_mask:0xf
    s_nop 0
    v_add_f32_dpp v30, v30, v30 quad_perm:[2,3,0,1] row_mask:0xf bank_mask:0xf
    v_add_f32_dpp v31, v31, v31 quad_perm:[2,3,0,1] row_mask:0xf bank_mask:0xf
    v_cvt_pk_bf16_f32 v42, v30, v31
    v_lshlrev_b32 v40, 16, v42
    v_and_b32 v41, s68, v42
    v_mul_f32 v40, s11, v40
    v_mul_f32 v41, s11, v41
    v_cvt_pk_bf16_f32 v42, v40, v41
    v_lshlrev_b32 v40, 16, v42
    v_and_b32 v41, s68, v42
    ds_write_b32 v62, v42 offset:16384
    v_max3_f32 v16, v16, v40, v41
    s_waitcnt vmcnt(6)
    v_dot2_f32_bf16 v18, v96, v8, 0
    v_dot2_f32_bf16 v18, v97, v9, v18
    v_dot2_f32_bf16 v18, v98, v10, v18
    v_dot2_f32_bf16 v18, v99, v11, v18
    buffer_load_dwordx4 v[116:119], v3, s[44:47], s69 offen offset:1024 nt
    s_mov_b32 s7, 69632
    buffer_load_dwordx4 v[208:211], v49, s[52:55], s7 offen offset:0
    s_waitcnt vmcnt(7)
    v_dot2_f32_bf16 v19, v100, v8, 0
    v_dot2_f32_bf16 v19, v101, v9, v19
    v_dot2_f32_bf16 v19, v102, v10, v19
    v_dot2_f32_bf16 v19, v103, v11, v19
    buffer_load_dwordx4 v[120:123], v3, s[44:47], s69 offen offset:2048 nt
    s_waitcnt vmcnt(6)
    v_dot2_f32_bf16 v20, v104, v8, 0
    v_dot2_f32_bf16 v20, v105, v9, v20
    v_dot2_f32_bf16 v20, v106, v10, v20
    v_dot2_f32_bf16 v20, v107, v11, v20
    buffer_load_dwordx4 v[124:127], v3, s[44:47], s69 offen offset:3072 nt
    buffer_load_dwordx4 v[212:215], v49, s[52:55], s7 offen offset:1024
    s_waitcnt vmcnt(7)
    v_dot2_f32_bf16 v21, v108, v8, 0
    v_dot2_f32_bf16 v21, v109, v9, v21
    v_dot2_f32_bf16 v21, v110, v10, v21
    v_dot2_f32_bf16 v21, v111, v11, v21
    s_add_u32 s8, s89, 262144
    s_and_b32 s8, s8, 0xfffff
    buffer_load_dwordx4 v[64:67], v2, s[44:47], s8 offen offset:0 nt
    s_waitcnt vmcnt(6)
    v_dot2_f32_bf16 v22, v112, v8, 0
    v_dot2_f32_bf16 v22, v113, v9, v22
    v_dot2_f32_bf16 v22, v114, v10, v22
    v_dot2_f32_bf16 v22, v115, v11, v22
    buffer_load_dwordx4 v[68:71], v2, s[44:47], s8 offen offset:1024 nt
    buffer_load_dwordx4 v[216:219], v49, s[52:55], s7 offen offset:2048
    s_waitcnt vmcnt(7)
    v_dot2_f32_bf16 v23, v116, v8, 0
    v_dot2_f32_bf16 v23, v117, v9, v23
    v_dot2_f32_bf16 v23, v118, v10, v23
    v_dot2_f32_bf16 v23, v119, v11, v23
    buffer_load_dwordx4 v[72:75], v2, s[44:47], s8 offen offset:2048 nt
    s_waitcnt vmcnt(6)
    v_dot2_f32_bf16 v24, v120, v8, 0
    v_dot2_f32_bf16 v24, v121, v9, v24
    v_dot2_f32_bf16 v24, v122, v10, v24
    v_dot2_f32_bf16 v24, v123, v11, v24
    buffer_load_dwordx4 v[76:79], v2, s[44:47], s8 offen offset:3072 nt
    buffer_load_dwordx4 v[220:223], v49, s[52:55], s7 offen offset:3072
    s_waitcnt vmcnt(7)
    v_dot2_f32_bf16 v25, v124, v8, 0
    v_dot2_f32_bf16 v25, v125, v9, v25
    v_dot2_f32_bf16 v25, v126, v10, v25
    v_dot2_f32_bf16 v25, v127, v11, v25
    buffer_load_dwordx4 v[80:83], v3, s[44:47], s8 offen offset:0 nt
    v_add_f32_dpp v26, v18, v18 row_mirror row_mask:0xf bank_mask:0x3
    v_add_f32_dpp v27, v19, v19 row_mirror row_mask:0xf bank_mask:0x3
    v_add_f32_dpp v28, v20, v20 row_mirror row_mask:0xf bank_mask:0x3
    v_add_f32_dpp v29, v21, v21 row_mirror row_mask:0xf bank_mask:0x3
    v_add_f32_dpp v26, v22, v22 row_mirror row_mask:0xf bank_mask:0xc
    v_add_f32_dpp v27, v23, v23 row_mirror row_mask:0xf bank_mask:0xc
    v_add_f32_dpp v28, v24, v24 row_mirror row_mask:0xf bank_mask:0xc
    v_add_f32_dpp v29, v25, v25 row_mirror row_mask:0xf bank_mask:0xc
    v_add_f32_dpp v30, v26, v26 row_half_mirror row_mask:0xf bank_mask:0x5
    v_add_f32_dpp v31, v27, v27 row_half_mirror row_mask:0xf bank_mask:0x5
    s_nop 0
    v_add_f32_dpp v30, v28, v28 row_half_mirror row_mask:0xf bank_mask:0xa
    v_add_f32_dpp v31, v29, v29 row_half_mirror row_mask:0xf bank_mask:0xa
    s_nop 0
    v_add_f32_dpp v30, v30, v30 quad_perm:[1,0,3,2] row_mask:0xf bank_mask:0xf
    v_add_f32_dpp v31, v31, v31 quad_perm:[1,0,3,2] row_mask:0xf bank_mask:0xf
    s_nop 0
    v_add_f32_dpp v30, v30, v30 quad_perm:[2,3,0,1] row_mask:0xf bank_mask:0xf
    v_add_f32_dpp v31, v31, v31 quad_perm:[2,3,0,1] row_mask:0xf bank_mask:0xf
    v_cvt_pk_bf16_f32 v42, v30, v31
    v_lshlrev_b32 v40, 16, v42
    v_and_b32 v41, s68, v42
    v_mul_f32 v40, s11, v40
    v_mul_f32 v41, s11, v41
    v_cvt_pk_bf16_f32 v42, v40, v41
    v_lshlrev_b32 v40, 16, v42
    v_and_b32 v41, s68, v42
    ds_write_b32 v62, v42 offset:16640
    v_max3_f32 v16, v16, v40, v41
    v_add_u32 v62, 512, v62
    s_waitcnt vmcnt(6)
    v_dot2_f32_bf16 v18, v64, v8, 0
    v_dot2_f32_bf16 v18, v65, v9, v18
    v_dot2_f32_bf16 v18, v66, v10, v18
    v_dot2_f32_bf16 v18, v67, v11, v18
    buffer_load_dwordx4 v[84:87], v3, s[44:47], s8 offen offset:1024 nt
    s_mov_b32 s7, 73728
    buffer_load_dwordx4 v[224:227], v49, s[52:55], s7 offen offset:0
    s_waitcnt vmcnt(7)
    v_dot2_f32_bf16 v19, v68, v8, 0
    v_dot2_f32_bf16 v19, v69, v9, v19
    v_dot2_f32_bf16 v19, v70, v10, v19
    v_dot2_f32_bf16 v19, v71, v11, v19
    buffer_load_dwordx4 v[88:91], v3, s[44:47], s8 offen offset:2048 nt
    s_waitcnt vmcnt(6)
    v_dot2_f32_bf16 v20, v72, v8, 0
    v_dot2_f32_bf16 v20, v73, v9, v20
    v_dot2_f32_bf16 v20, v74, v10, v20
    v_dot2_f32_bf16 v20, v75, v11, v20
    buffer_load_dwordx4 v[92:95], v3, s[44:47], s8 offen offset:3072 nt
    buffer_load_dwordx4 v[228:231], v49, s[52:55], s7 offen offset:1024
    s_waitcnt vmcnt(7)
    v_dot2_f32_bf16 v21, v76, v8, 0
    v_dot2_f32_bf16 v21, v77, v9, v21
    v_dot2_f32_bf16 v21, v78, v10, v21
    v_dot2_f32_bf16 v21, v79, v11, v21
    s_add_u32 s69, s89, 294912
    s_and_b32 s69, s69, 0xfffff
    buffer_load_dwordx4 v[96:99], v2, s[44:47], s69 offen offset:0 nt
    s_waitcnt vmcnt(6)
    v_dot2_f32_bf16 v22, v80, v8, 0
    v_dot2_f32_bf16 v22, v81, v9, v22
    v_dot2_f32_bf16 v22, v82, v10, v22
    v_dot2_f32_bf16 v22, v83, v11, v22
    buffer_load_dwordx4 v[100:103], v2, s[44:47], s69 offen offset:1024 nt
    buffer_load_dwordx4 v[232:235], v49, s[52:55], s7 offen offset:2048
    s_waitcnt vmcnt(7)
    v_dot2_f32_bf16 v23, v84, v8, 0
    v_dot2_f32_bf16 v23, v85, v9, v23
    v_dot2_f32_bf16 v23, v86, v10, v23
    v_dot2_f32_bf16 v23, v87, v11, v23
    buffer_load_dwordx4 v[104:107], v2, s[44:47], s69 offen offset:2048 nt
    s_waitcnt vmcnt(6)
    v_dot2_f32_bf16 v24, v88, v8, 0
    v_dot2_f32_bf16 v24, v89, v9, v24
    v_dot2_f32_bf16 v24, v90, v10, v24
    v_dot2_f32_bf16 v24, v91, v11, v24
    buffer_load_dwordx4 v[108:111], v2, s[44:47], s69 offen offset:3072 nt
    buffer_load_dwordx4 v[236:239], v49, s[52:55], s7 offen offset:3072
    s_waitcnt vmcnt(7)
    v_dot2_f32_bf16 v25, v92, v8, 0
    v_dot2_f32_bf16 v25, v93, v9, v25
    v_dot2_f32_bf16 v25, v94, v10, v25
    v_dot2_f32_bf16 v25, v95, v11, v25
    buffer_load_dwordx4 v[112:115], v3, s[44:47], s69 offen offset:0 nt
    v_add_f32_dpp v26, v18, v18 row_mirror row_mask:0xf bank_mask:0x3
    v_add_f32_dpp v27, v19, v19 row_mirror row_mask:0xf bank_mask:0x3
    v_add_f32_dpp v28, v20, v20 row_mirror row_mask:0xf bank_mask:0x3
    v_add_f32_dpp v29, v21, v21 row_mirror row_mask:0xf bank_mask:0x3
    v_add_f32_dpp v26, v22, v22 row_mirror row_mask:0xf bank_mask:0xc
    v_add_f32_dpp v27, v23, v23 row_mirror row_mask:0xf bank_mask:0xc
    v_add_f32_dpp v28, v24, v24 row_mirror row_mask:0xf bank_mask:0xc
    v_add_f32_dpp v29, v25, v25 row_mirror row_mask:0xf bank_mask:0xc
    v_add_f32_dpp v30, v26, v26 row_half_mirror row_mask:0xf bank_mask:0x5
    v_add_f32_dpp v31, v27, v27 row_half_mirror row_mask:0xf bank_mask:0x5
    s_nop 0
    v_add_f32_dpp v30, v28, v28 row_half_mirror row_mask:0xf bank_mask:0xa
    v_add_f32_dpp v31, v29, v29 row_half_mirror row_mask:0xf bank_mask:0xa
    s_nop 0
    v_add_f32_dpp v30, v30, v30 quad_perm:[1,0,3,2] row_mask:0xf bank_mask:0xf
    v_add_f32_dpp v31, v31, v31 quad_perm:[1,0,3,2] row_mask:0xf bank_mask:0xf
    s_nop 0
    v_add_f32_dpp v30, v30, v30 quad_perm:[2,3,0,1] row_mask:0xf bank_mask:0xf
    v_add_f32_dpp v31, v31, v31 quad_perm:[2,3,0,1] row_mask:0xf bank_mask:0xf
    v_cvt_pk_bf16_f32 v42, v30, v31
    v_lshlrev_b32 v40, 16, v42
    v_and_b32 v41, s68, v42
    v_mul_f32 v40, s11, v40
    v_mul_f32 v41, s11, v41
    v_cvt_pk_bf16_f32 v42, v40, v41
    v_lshlrev_b32 v40, 16, v42
    v_and_b32 v41, s68, v42
    ds_write_b32 v62, v42 offset:16384
    v_max3_f32 v16, v16, v40, v41
    s_waitcnt vmcnt(6)
    v_dot2_f32_bf16 v18, v96, v8, 0
    v_dot2_f32_bf16 v18, v97, v9, v18
    v_dot2_f32_bf16 v18, v98, v10, v18
    v_dot2_f32_bf16 v18, v99, v11, v18
    buffer_load_dwordx4 v[116:119], v3, s[44:47], s69 offen offset:1024 nt
    s_mov_b32 s7, 77824
    buffer_load_dwordx4 v[240:243], v49, s[52:55], s7 offen offset:0
    s_waitcnt vmcnt(7)
    v_dot2_f32_bf16 v19, v100, v8, 0
    v_dot2_f32_bf16 v19, v101, v9, v19
    v_dot2_f32_bf16 v19, v102, v10, v19
    v_dot2_f32_bf16 v19, v103, v11, v19
    buffer_load_dwordx4 v[120:123], v3, s[44:47], s69 offen offset:2048 nt
    s_waitcnt vmcnt(6)
    v_dot2_f32_bf16 v20, v104, v8, 0
    v_dot2_f32_bf16 v20, v105, v9, v20
    v_dot2_f32_bf16 v20, v106, v10, v20
    v_dot2_f32_bf16 v20, v107, v11, v20
    buffer_load_dwordx4 v[124:127], v3, s[44:47], s69 offen offset:3072 nt
    buffer_load_dwordx4 v[244:247], v49, s[52:55], s7 offen offset:1024
    s_waitcnt vmcnt(7)
    v_dot2_f32_bf16 v21, v108, v8, 0
    v_dot2_f32_bf16 v21, v109, v9, v21
    v_dot2_f32_bf16 v21, v110, v10, v21
    v_dot2_f32_bf16 v21, v111, v11, v21
    s_add_u32 s8, s89, 327680
    s_and_b32 s8, s8, 0xfffff
    buffer_load_dwordx4 v[64:67], v2, s[44:47], s8 offen offset:0 nt
    s_waitcnt vmcnt(6)
    v_dot2_f32_bf16 v22, v112, v8, 0
    v_dot2_f32_bf16 v22, v113, v9, v22
    v_dot2_f32_bf16 v22, v114, v10, v22
    v_dot2_f32_bf16 v22, v115, v11, v22
    buffer_load_dwordx4 v[68:71], v2, s[44:47], s8 offen offset:1024 nt
    buffer_load_dwordx4 v[248:251], v49, s[52:55], s7 offen offset:2048
    s_waitcnt vmcnt(7)
    v_dot2_f32_bf16 v23, v116, v8, 0
    v_dot2_f32_bf16 v23, v117, v9, v23
    v_dot2_f32_bf16 v23, v118, v10, v23
    v_dot2_f32_bf16 v23, v119, v11, v23
    buffer_load_dwordx4 v[72:75], v2, s[44:47], s8 offen offset:2048 nt
    s_waitcnt vmcnt(6)
    v_dot2_f32_bf16 v24, v120, v8, 0
    v_dot2_f32_bf16 v24, v121, v9, v24
    v_dot2_f32_bf16 v24, v122, v10, v24
    v_dot2_f32_bf16 v24, v123, v11, v24
    buffer_load_dwordx4 v[76:79], v2, s[44:47], s8 offen offset:3072 nt
    buffer_load_dwordx4 v[252:255], v49, s[52:55], s7 offen offset:3072
    s_waitcnt vmcnt(7)
    v_dot2_f32_bf16 v25, v124, v8, 0
    v_dot2_f32_bf16 v25, v125, v9, v25
    v_dot2_f32_bf16 v25, v126, v10, v25
    v_dot2_f32_bf16 v25, v127, v11, v25
    buffer_load_dwordx4 v[80:83], v3, s[44:47], s8 offen offset:0 nt
    v_add_f32_dpp v26, v18, v18 row_mirror row_mask:0xf bank_mask:0x3
    v_add_f32_dpp v27, v19, v19 row_mirror row_mask:0xf bank_mask:0x3
    v_add_f32_dpp v28, v20, v20 row_mirror row_mask:0xf bank_mask:0x3
    v_add_f32_dpp v29, v21, v21 row_mirror row_mask:0xf bank_mask:0x3
    v_add_f32_dpp v26, v22, v22 row_mirror row_mask:0xf bank_mask:0xc
    v_add_f32_dpp v27, v23, v23 row_mirror row_mask:0xf bank_mask:0xc
    v_add_f32_dpp v28, v24, v24 row_mirror row_mask:0xf bank_mask:0xc
    v_add_f32_dpp v29, v25, v25 row_mirror row_mask:0xf bank_mask:0xc
    v_add_f32_dpp v30, v26, v26 row_half_mirror row_mask:0xf bank_mask:0x5
    v_add_f32_dpp v31, v27, v27 row_half_mirror row_mask:0xf bank_mask:0x5
    s_nop 0
    v_add_f32_dpp v30, v28, v28 row_half_mirror row_mask:0xf bank_mask:0xa
    v_add_f32_dpp v31, v29, v29 row_half_mirror row_mask:0xf bank_mask:0xa
    s_nop 0
    v_add_f32_dpp v30, v30, v30 quad_perm:[1,0,3,2] row_mask:0xf bank_mask:0xf
    v_add_f32_dpp v31, v31, v31 quad_perm:[1,0,3,2] row_mask:0xf bank_mask:0xf
    s_nop 0
    v_add_f32_dpp v30, v30, v30 quad_perm:[2,3,0,1] row_mask:0xf bank_mask:0xf
    v_add_f32_dpp v31, v31, v31 quad_perm:[2,3,0,1] row_mask:0xf bank_mask:0xf
    v_cvt_pk_bf16_f32 v42, v30, v31
    v_lshlrev_b32 v40, 16, v42
    v_and_b32 v41, s68, v42
    v_mul_f32 v40, s11, v40
    v_mul_f32 v41, s11, v41
    v_cvt_pk_bf16_f32 v42, v40, v41
    v_lshlrev_b32 v40, 16, v42
    v_and_b32 v41, s68, v42
    ds_write_b32 v62, v42 offset:16640
    v_max3_f32 v16, v16, v40, v41
    v_add_u32 v62, 512, v62
    s_waitcnt vmcnt(6)
    v_dot2_f32_bf16 v18, v64, v8, 0
    v_dot2_f32_bf16 v18, v65, v9, v18
    v_dot2_f32_bf16 v18, v66, v10, v18
    v_dot2_f32_bf16 v18, v67, v11, v18
    buffer_load_dwordx4 v[84:87], v3, s[44:47], s8 offen offset:1024 nt
    s_waitcnt vmcnt(6)
    v_dot2_f32_bf16 v19, v68, v8, 0
    v_dot2_f32_bf16 v19, v69, v9, v19
    v_dot2_f32_bf16 v19, v70, v10, v19
    v_dot2_f32_bf16 v19, v71, v11, v19
    buffer_load_dwordx4 v[88:91], v3, s[44:47], s8 offen offset:2048 nt
    s_waitcnt vmcnt(5)
    v_dot2_f32_bf16 v20, v72, v8, 0
    v_dot2_f32_bf16 v20, v73, v9, v20
    v_dot2_f32_bf16 v20, v74, v10, v20
    v_dot2_f32_bf16 v20, v75, v11, v20
    buffer_load_dwordx4 v[92:95], v3, s[44:47], s8 offen offset:3072 nt
    s_waitcnt vmcnt(5)
    v_dot2_f32_bf16 v21, v76, v8, 0
    v_dot2_f32_bf16 v21, v77, v9, v21
    v_dot2_f32_bf16 v21, v78, v10, v21
    v_dot2_f32_bf16 v21, v79, v11, v21
    s_add_u32 s69, s89, 360448
    s_and_b32 s69, s69, 0xfffff
    buffer_load_dwordx4 v[96:99], v2, s[44:47], s69 offen offset:0 nt
    s_waitcnt vmcnt(4)
    v_dot2_f32_bf16 v22, v80, v8, 0
    v_dot2_f32_bf16 v22, v81, v9, v22
    v_dot2_f32_bf16 v22, v82, v10, v22
    v_dot2_f32_bf16 v22, v83, v11, v22
    buffer_load_dwordx4 v[100:103], v2, s[44:47], s69 offen offset:1024 nt
    s_waitcnt vmcnt(4)
    v_dot2_f32_bf16 v23, v84, v8, 0
    v_dot2_f32_bf16 v23, v85, v9, v23
    v_dot2_f32_bf16 v23, v86, v10, v23
    v_dot2_f32_bf16 v23, v87, v11, v23
    buffer_load_dwordx4 v[104:107], v2, s[44:47], s69 offen offset:2048 nt
    s_waitcnt vmcnt(4)
    v_dot2_f32_bf16 v24, v88, v8, 0
    v_dot2_f32_bf16 v24, v89, v9, v24
    v_dot2_f32_bf16 v24, v90, v10, v24
    v_dot2_f32_bf16 v24, v91, v11, v24
    buffer_load_dwordx4 v[108:111], v2, s[44:47], s69 offen offset:3072 nt
    s_waitcnt vmcnt(4)
    v_dot2_f32_bf16 v25, v92, v8, 0
    v_dot2_f32_bf16 v25, v93, v9, v25
    v_dot2_f32_bf16 v25, v94, v10, v25
    v_dot2_f32_bf16 v25, v95, v11, v25
    buffer_load_dwordx4 v[112:115], v3, s[44:47], s69 offen offset:0 nt
    v_add_f32_dpp v26, v18, v18 row_mirror row_mask:0xf bank_mask:0x3
    v_add_f32_dpp v27, v19, v19 row_mirror row_mask:0xf bank_mask:0x3
    v_add_f32_dpp v28, v20, v20 row_mirror row_mask:0xf bank_mask:0x3
    v_add_f32_dpp v29, v21, v21 row_mirror row_mask:0xf bank_mask:0x3
    v_add_f32_dpp v26, v22, v22 row_mirror row_mask:0xf bank_mask:0xc
    v_add_f32_dpp v27, v23, v23 row_mirror row_mask:0xf bank_mask:0xc
    v_add_f32_dpp v28, v24, v24 row_mirror row_mask:0xf bank_mask:0xc
    v_add_f32_dpp v29, v25, v25 row_mirror row_mask:0xf bank_mask:0xc
    v_add_f32_dpp v30, v26, v26 row_half_mirror row_mask:0xf bank_mask:0x5
    v_add_f32_dpp v31, v27, v27 row_half_mirror row_mask:0xf bank_mask:0x5
    s_nop 0
    v_add_f32_dpp v30, v28, v28 row_half_mirror row_mask:0xf bank_mask:0xa
    v_add_f32_dpp v31, v29, v29 row_half_mirror row_mask:0xf bank_mask:0xa
    s_nop 0
    v_add_f32_dpp v30, v30, v30 quad_perm:[1,0,3,2] row_mask:0xf bank_mask:0xf
    v_add_f32_dpp v31, v31, v31 quad_perm:[1,0,3,2] row_mask:0xf bank_mask:0xf
    s_nop 0
    v_add_f32_dpp v30, v30, v30 quad_perm:[2,3,0,1] row_mask:0xf bank_mask:0xf
    v_add_f32_dpp v31, v31, v31 quad_perm:[2,3,0,1] row_mask:0xf bank_mask:0xf
    v_cvt_pk_bf16_f32 v42, v30, v31
    v_lshlrev_b32 v40, 16, v42
    v_and_b32 v41, s68, v42
    v_mul_f32 v40, s11, v40
    v_mul_f32 v41, s11, v41
    v_cvt_pk_bf16_f32 v42, v40, v41
    v_lshlrev_b32 v40, 16, v42
    v_and_b32 v41, s68, v42
    ds_write_b32 v62, v42 offset:16384
    v_max3_f32 v16, v16, v40, v41
    s_waitcnt vmcnt(4)
    v_dot2_f32_bf16 v18, v96, v8, 0
    v_dot2_f32_bf16 v18, v97, v9, v18
    v_dot2_f32_bf16 v18, v98, v10, v18
    v_dot2_f32_bf16 v18, v99, v11, v18
    buffer_load_dwordx4 v[116:119], v3, s[44:47], s69 offen offset:1024 nt
    s_waitcnt vmcnt(4)
    v_dot2_f32_bf16 v19, v100, v8, 0
    v_dot2_f32_bf16 v19, v101, v9, v19
    v_dot2_f32_bf16 v19, v102, v10, v19
    v_dot2_f32_bf16 v19, v103, v11, v19
    buffer_load_dwordx4 v[120:123], v3, s[44:47], s69 offen offset:2048 nt
    s_waitcnt vmcnt(4)
    v_dot2_f32_bf16 v20, v104, v8, 0
    v_dot2_f32_bf16 v20, v105, v9, v20
    v_dot2_f32_bf16 v20, v106, v10, v20
    v_dot2_f32_bf16 v20, v107, v11, v20
    buffer_load_dwordx4 v[124:127], v3, s[44:47], s69 offen offset:3072 nt
    s_waitcnt vmcnt(4)
    v_dot2_f32_bf16 v21, v108, v8, 0
    v_dot2_f32_bf16 v21, v109, v9, v21
    v_dot2_f32_bf16 v21, v110, v10, v21
    v_dot2_f32_bf16 v21, v111, v11, v21
    s_add_u32 s8, s89, 393216
    s_and_b32 s8, s8, 0xfffff
    buffer_load_dwordx4 v[64:67], v2, s[44:47], s8 offen offset:0 nt
    s_waitcnt vmcnt(4)
    v_dot2_f32_bf16 v22, v112, v8, 0
    v_dot2_f32_bf16 v22, v113, v9, v22
    v_dot2_f32_bf16 v22, v114, v10, v22
    v_dot2_f32_bf16 v22, v115, v11, v22
    buffer_load_dwordx4 v[68:71], v2, s[44:47], s8 offen offset:1024 nt
    s_waitcnt vmcnt(4)
    v_dot2_f32_bf16 v23, v116, v8, 0
    v_dot2_f32_bf16 v23, v117, v9, v23
    v_dot2_f32_bf16 v23, v118, v10, v23
    v_dot2_f32_bf16 v23, v119, v11, v23
    buffer_load_dwordx4 v[72:75], v2, s[44:47], s8 offen offset:2048 nt
    s_waitcnt vmcnt(4)
    v_dot2_f32_bf16 v24, v120, v8, 0
    v_dot2_f32_bf16 v24, v121, v9, v24
    v_dot2_f32_bf16 v24, v122, v10, v24
    v_dot2_f32_bf16 v24, v123, v11, v24
    buffer_load_dwordx4 v[76:79], v2, s[44:47], s8 offen offset:3072 nt
    s_waitcnt vmcnt(4)
    v_dot2_f32_bf16 v25, v124, v8, 0
    v_dot2_f32_bf16 v25, v125, v9, v25
    v_dot2_f32_bf16 v25, v126, v10, v25
    v_dot2_f32_bf16 v25, v127, v11, v25
    buffer_load_dwordx4 v[80:83], v3, s[44:47], s8 offen offset:0 nt
    v_add_f32_dpp v26, v18, v18 row_mirror row_mask:0xf bank_mask:0x3
    v_add_f32_dpp v27, v19, v19 row_mirror row_mask:0xf bank_mask:0x3
    v_add_f32_dpp v28, v20, v20 row_mirror row_mask:0xf bank_mask:0x3
    v_add_f32_dpp v29, v21, v21 row_mirror row_mask:0xf bank_mask:0x3
    v_add_f32_dpp v26, v22, v22 row_mirror row_mask:0xf bank_mask:0xc
    v_add_f32_dpp v27, v23, v23 row_mirror row_mask:0xf bank_mask:0xc
    v_add_f32_dpp v28, v24, v24 row_mirror row_mask:0xf bank_mask:0xc
    v_add_f32_dpp v29, v25, v25 row_mirror row_mask:0xf bank_mask:0xc
    v_add_f32_dpp v30, v26, v26 row_half_mirror row_mask:0xf bank_mask:0x5
    v_add_f32_dpp v31, v27, v27 row_half_mirror row_mask:0xf bank_mask:0x5
    s_nop 0
    v_add_f32_dpp v30, v28, v28 row_half_mirror row_mask:0xf bank_mask:0xa
    v_add_f32_dpp v31, v29, v29 row_half_mirror row_mask:0xf bank_mask:0xa
    s_nop 0
    v_add_f32_dpp v30, v30, v30 quad_perm:[1,0,3,2] row_mask:0xf bank_mask:0xf
    v_add_f32_dpp v31, v31, v31 quad_perm:[1,0,3,2] row_mask:0xf bank_mask:0xf
    s_nop 0
    v_add_f32_dpp v30, v30, v30 quad_perm:[2,3,0,1] row_mask:0xf bank_mask:0xf
    v_add_f32_dpp v31, v31, v31 quad_perm:[2,3,0,1] row_mask:0xf bank_mask:0xf
    v_cvt_pk_bf16_f32 v42, v30, v31
    v_lshlrev_b32 v40, 16, v42
    v_and_b32 v41, s68, v42
    v_mul_f32 v40, s11, v40
    v_mul_f32 v41, s11, v41
    v_cvt_pk_bf16_f32 v42, v40, v41
    v_lshlrev_b32 v40, 16, v42
    v_and_b32 v41, s68, v42
    ds_write_b32 v62, v42 offset:16640
    v_max3_f32 v16, v16, v40, v41
    v_add_u32 v62, 512, v62
    s_add_u32 s8, s89, 393216
    s_and_b32 s8, s8, 0xfffff
    s_add_u32 s69, s89, 425984
    s_and_b32 s69, s69, 0xfffff
    s_mov_b32 s9, 8
L_kloop:
    s_waitcnt vmcnt(4)
    v_dot2_f32_bf16 v18, v64, v8, 0
    v_dot2_f32_bf16 v18, v65, v9, v18
    v_dot2_f32_bf16 v18, v66, v10, v18
    v_dot2_f32_bf16 v18, v67, v11, v18
    buffer_load_dwordx4 v[84:87], v3, s[44:47], s8 offen offset:1024 nt
    s_waitcnt vmcnt(4)
    v_dot2_f32_bf16 v19, v68, v8, 0
    v_dot2_f32_bf16 v19, v69, v9, v19
    v_dot2_f32_bf16 v19, v70, v10, v19
    v_dot2_f32_bf16 v19, v71, v11, v19
    buffer_load_dwordx4 v[88:91], v3, s[44:47], s8 offen offset:2048 nt
    s_waitcnt vmcnt(4)
    v_dot2_f32_bf16 v20, v72, v8, 0
    v_dot2_f32_bf16 v20, v73, v9, v20
    v_dot2_f32_bf16 v20, v74, v10, v20
    v_dot2_f32_bf16 v20, v75, v11, v20
    buffer_load_dwordx4 v[92:95], v3, s[44:47], s8 offen offset:3072 nt
    s_waitcnt vmcnt(4)
    v_dot2_f32_bf16 v21, v76, v8, 0
    v_dot2_f32_bf16 v21, v77, v9, v21
    v_dot2_f32_bf16 v21, v78, v10, v21
    v_dot2_f32_bf16 v21, v79, v11, v21
    buffer_load_dwordx4 v[96:99], v2, s[44:47], s69 offen offset:0 nt
    s_waitcnt vmcnt(4)
    v_dot2_f32_bf16 v22, v80, v8, 0
    v_dot2_f32_bf16 v22, v81, v9, v22
    v_dot2_f32_bf16 v22, v82, v10, v22
    v_dot2_f32_bf16 v22, v83, v11, v22
    buffer_load_dwordx4 v[100:103], v2, s[44:47], s69 offen offset:1024 nt
    s_waitcnt vmcnt(4)
    v_dot2_f32_bf16 v23, v84, v8, 0
    v_dot2_f32_bf16 v23, v85, v9, v23
    v_dot2_f32_bf16 v23, v86, v10, v23
    v_dot2_f32_bf16 v23, v87, v11, v23
    buffer_load_dwordx4 v[104:107], v2, s[44:47], s69 offen offset:2048 nt
    s_waitcnt vmcnt(4)
    v_dot2_f32_bf16 v24, v88, v8, 0
    v_dot2_f32_bf16 v24, v89, v9, v24
    v_dot2_f32_bf16 v24, v90, v10, v24
    v_dot2_f32_bf16 v24, v91, v11, v24
    buffer_load_dwordx4 v[108:111], v2, s[44:47], s69 offen offset:3072 nt
    s_waitcnt vmcnt(4)
    v_dot2_f32_bf16 v25, v92, v8, 0
    v_dot2_f32_bf16 v25, v93, v9, v25
    v_dot2_f32_bf16 v25, v94, v10, v25
    v_dot2_f32_bf16 v25, v95, v11, v25
    buffer_load_dwordx4 v[112:115], v3, s[44:47], s69 offen offset:0 nt
    v_add_f32_dpp v26, v18, v18 row_mirror row_mask:0xf bank_mask:0x3
    v_add_f32_dpp v27, v19, v19 row_mirror row_mask:0xf bank_mask:0x3
    v_add_f32_dpp v28, v20, v20 row_mirror row_mask:0xf bank_mask:0x3
    v_add_f32_dpp v29, v21, v21 row_mirror row_mask:0xf bank_mask:0x3
    v_add_f32_dpp v26, v22, v22 row_mirror row_mask:0xf bank_mask:0xc
    v_add_f32_dpp v27, v23, v23 row_mirror row_mask:0xf bank_mask:0xc
    v_add_f32_dpp v28, v24, v24 row_mirror row_mask:0xf bank_mask:0xc
    v_add_f32_dpp v29, v25, v25 row_mirror row_mask:0xf bank_mask:0xc
    v_add_f32_dpp v30, v26, v26 row_half_mirror row_mask:0xf bank_mask:0x5
    v_add_f32_dpp v31, v27, v27 row_half_mirror row_mask:0xf bank_mask:0x5
    s_nop 0
    v_add_f32_dpp v30, v28, v28 row_half_mirror row_mask:0xf bank_mask:0xa
    v_add_f32_dpp v31, v29, v29 row_half_mirror row_mask:0xf bank_mask:0xa
    s_nop 0
    v_add_f32_dpp v30, v30, v30 quad_perm:[1,0,3,2] row_mask:0xf bank_mask:0xf
    v_add_f32_dpp v31, v31, v31 quad_perm:[1,0,3,2] row_mask:0xf bank_mask:0xf
    s_nop 0
    v_add_f32_dpp v30, v30, v30 quad_perm:[2,3,0,1] row_mask:0xf bank_mask:0xf
    v_add_f32_dpp v31, v31, v31 quad_perm:[2,3,0,1] row_mask:0xf bank_mask:0xf
    v_cvt_pk_bf16_f32 v42, v30, v31
    v_lshlrev_b32 v40, 16, v42
    v_and_b32 v41, s68, v42
    v_mul_f32 v40, s11, v40
    v_mul_f32 v41, s11, v41
    v_cvt_pk_bf16_f32 v42, v40, v41
    v_lshlrev_b32 v40, 16, v42
    v_and_b32 v41, s68, v42
    ds_write_b32 v62, v42 offset:16384
    v_max3_f32 v16, v16, v40, v41
    s_mov_b32 s8, s69
    s_add_u32 s69, s69, 32768
    s_and_b32 s69, s69, 0xfffff
    s_waitcnt vmcnt(4)
    v_dot2_f32_bf16 v18, v96, v8, 0
    v_dot2_f32_bf16 v18, v97, v9, v18
    v_dot2_f32_bf16 v18, v98, v10, v18
    v_dot2_f32_bf16 v18, v99, v11, v18
    buffer_load_dwordx4 v[116:119], v3, s[44:47], s8 offen offset:1024 nt
    s_waitcnt vmcnt(4)
    v_dot2_f32_bf16 v19, v100, v8, 0
    v_dot2_f32_bf16 v19, v101, v9, v19
    v_dot2_f32_bf16 v19, v102, v10, v19
    v_dot2_f32_bf16 v19, v103, v11, v19
    buffer_load_dwordx4 v[120:123], v3, s[44:47], s8 offen offset:2048 nt
    s_waitcnt vmcnt(4)
    v_dot2_f32_bf16 v20, v104, v8, 0
    v_dot2_f32_bf16 v20, v105, v9, v20
    v_dot2_f32_bf16 v20, v106, v10, v20
    v_dot2_f32_bf16 v20, v107, v11, v20
    buffer_load_dwordx4 v[124:127], v3, s[44:47], s8 offen offset:3072 nt
    s_waitcnt vmcnt(4)
    v_dot2_f32_bf16 v21, v108, v8, 0
    v_dot2_f32_bf16 v21, v109, v9, v21
    v_dot2_f32_bf16 v21, v110, v10, v21
    v_dot2_f32_bf16 v21, v111, v11, v21
    buffer_load_dwordx4 v[64:67], v2, s[44:47], s69 offen offset:0 nt
    s_waitcnt vmcnt(4)
    v_dot2_f32_bf16 v22, v112, v8, 0
    v_dot2_f32_bf16 v22, v113, v9, v22
    v_dot2_f32_bf16 v22, v114, v10, v22
    v_dot2_f32_bf16 v22, v115, v11, v22
    buffer_load_dwordx4 v[68:71], v2, s[44:47], s69 offen offset:1024 nt
    s_waitcnt vmcnt(4)
    v_dot2_f32_bf16 v23, v116, v8, 0
    v_dot2_f32_bf16 v23, v117, v9, v23
    v_dot2_f32_bf16 v23, v118, v10, v23
    v_dot2_f32_bf16 v23, v119, v11, v23
    buffer_load_dwordx4 v[72:75], v2, s[44:47], s69 offen offset:2048 nt
    s_waitcnt vmcnt(4)
    v_dot2_f32_bf16 v24, v120, v8, 0
    v_dot2_f32_bf16 v24, v121, v9, v24
    v_dot2_f32_bf16 v24, v122, v10, v24
    v_dot2_f32_bf16 v24, v123, v11, v24
    buffer_load_dwordx4 v[76:79], v2, s[44:47], s69 offen offset:3072 nt
    s_waitcnt vmcnt(4)
    v_dot2_f32_bf16 v25, v124, v8, 0
    v_dot2_f32_bf16 v25, v125, v9, v25
    v_dot2_f32_bf16 v25, v126, v10, v25
    v_dot2_f32_bf16 v25, v127, v11, v25
    buffer_load_dwordx4 v[80:83], v3, s[44:47], s69 offen offset:0 nt
    v_add_f32_dpp v26, v18, v18 row_mirror row_mask:0xf bank_mask:0x3
    v_add_f32_dpp v27, v19, v19 row_mirror row_mask:0xf bank_mask:0x3
    v_add_f32_dpp v28, v20, v20 row_mirror row_mask:0xf bank_mask:0x3
    v_add_f32_dpp v29, v21, v21 row_mirror row_mask:0xf bank_mask:0x3
    v_add_f32_dpp v26, v22, v22 row_mirror row_mask:0xf bank_mask:0xc
    v_add_f32_dpp v27, v23, v23 row_mirror row_mask:0xf bank_mask:0xc
    v_add_f32_dpp v28, v24, v24 row_mirror row_mask:0xf bank_mask:0xc
    v_add_f32_dpp v29, v25, v25 row_mirror row_mask:0xf bank_mask:0xc
    v_add_f32_dpp v30, v26, v26 row_half_mirror row_mask:0xf bank_mask:0x5
    v_add_f32_dpp v31, v27, v27 row_half_mirror row_mask:0xf bank_mask:0x5
    s_nop 0
    v_add_f32_dpp v30, v28, v28 row_half_mirror row_mask:0xf bank_mask:0xa
    v_add_f32_dpp v31, v29, v29 row_half_mirror row_mask:0xf bank_mask:0xa
    s_nop 0
    v_add_f32_dpp v30, v30, v30 quad_perm:[1,0,3,2] row_mask:0xf bank_mask:0xf
    v_add_f32_dpp v31, v31, v31 quad_perm:[1,0,3,2] row_mask:0xf bank_mask:0xf
    s_nop 0
    v_add_f32_dpp v30, v30, v30 quad_perm:[2,3,0,1] row_mask:0xf bank_mask:0xf
    v_add_f32_dpp v31, v31, v31 quad_perm:[2,3,0,1] row_mask:0xf bank_mask:0xf
    v_cvt_pk_bf16_f32 v42, v30, v31
    v_lshlrev_b32 v40, 16, v42
    v_and_b32 v41, s68, v42
    v_mul_f32 v40, s11, v40
    v_mul_f32 v41, s11, v41
    v_cvt_pk_bf16_f32 v42, v40, v41
    v_lshlrev_b32 v40, 16, v42
    v_and_b32 v41, s68, v42
    ds_write_b32 v62, v42 offset:16640
    v_max3_f32 v16, v16, v40, v41
    s_mov_b32 s8, s69
    s_add_u32 s69, s69, 32768
    s_and_b32 s69, s69, 0xfffff
    v_add_u32 v62, 512, v62
    s_sub_u32 s9, s9, 1
    s_cmp_lg_u32 s9, 0
    s_cbranch_scc1 L_kloop
    s_mov_b32 s56, s16
    s_and_b32 s57, s17, 0xffff
    s_mov_b32 s58, 4096
    s_mov_b32 s59, 0x20000
    s_mov_b32 s52, s34
    s_and_b32 s53, s35, 0xffff
    s_mov_b32 s54, 1024
    s_lshl_b32 s14, s5, 10
    v_lshlrev_b32 v54, 2, v0
    v_add_u32 v55, s14, v54
    buffer_load_dword v57, v55, s[56:59], 0 offen
    buffer_load_dword v58, v54, s[52:55], 0 offen
    s_waitcnt vmcnt(6)
    v_dot2_f32_bf16 v18, v64, v8, 0
    v_dot2_f32_bf16 v18, v65, v9, v18
    v_dot2_f32_bf16 v18, v66, v10, v18
    v_dot2_f32_bf16 v18, v67, v11, v18
    s_add_u32 s8, s89, 917504
    s_and_b32 s8, s8, 0xfffff
    buffer_load_dwordx4 v[84:87], v3, s[44:47], s8 offen offset:1024 nt
    s_waitcnt vmcnt(6)
    v_dot2_f32_bf16 v19, v68, v8, 0
    v_dot2_f32_bf16 v19, v69, v9, v19
    v_dot2_f32_bf16 v19, v70, v10, v19
    v_dot2_f32_bf16 v19, v71, v11, v19
    buffer_load_dwordx4 v[88:91], v3, s[44:47], s8 offen offset:2048 nt
    s_waitcnt vmcnt(6)
    v_dot2_f32_bf16 v20, v72, v8, 0
    v_dot2_f32_bf16 v20, v73, v9, v20
    v_dot2_f32_bf16 v20, v74, v10, v20
    v_dot2_f32_bf16 v20, v75, v11, v20
    buffer_load_dwordx4 v[92:95], v3, s[44:47], s8 offen offset:3072 nt
    s_waitcnt vmcnt(6)
    v_dot2_f32_bf16 v21, v76, v8, 0
    v_dot2_f32_bf16 v21, v77, v9, v21
    v_dot2_f32_bf16 v21, v78, v10, v21
    v_dot2_f32_bf16 v21, v79, v11, v21
    s_add_u32 s69, s89, 950272
    s_and_b32 s69, s69, 0xfffff
    buffer_load_dwordx4 v[96:99], v2, s[44:47], s69 offen offset:0 nt
    s_waitcnt vmcnt(6)
    v_dot2_f32_bf16 v22, v80, v8, 0
    v_dot2_f32_bf16 v22, v81, v9, v22
    v_dot2_f32_bf16 v22, v82, v10, v22
    v_dot2_f32_bf16 v22, v83, v11, v22
    buffer_load_dwordx4 v[100:103], v2, s[44:47], s69 offen offset:1024 nt
    s_waitcnt vmcnt(4)
    v_dot2_f32_bf16 v23, v84, v8, 0
    v_dot2_f32_bf16 v23, v85, v9, v23
    v_dot2_f32_bf16 v23, v86, v10, v23
    v_dot2_f32_bf16 v23, v87, v11, v23
    buffer_load_dwordx4 v[104:107], v2, s[44:47], s69 offen offset:2048 nt
    s_waitcnt vmcnt(4)
    v_dot2_f32_bf16 v24, v88, v8, 0
    v_dot2_f32_bf16 v24, v89, v9, v24
    v_dot2_f32_bf16 v24, v90, v10, v24
    v_dot2_f32_bf16 v24, v91, v11, v24
    buffer_load_dwordx4 v[108:111], v2, s[44:47], s69 offen offset:3072 nt
    s_waitcnt vmcnt(4)
    v_dot2_f32_bf16 v25, v92, v8, 0
    v_dot2_f32_bf16 v25, v93, v9, v25
    v_dot2_f32_bf16 v25, v94, v10, v25
    v_dot2_f32_bf16 v25, v95, v11, v25
    buffer_load_dwordx4 v[112:115], v3, s[44:47], s69 offen offset:0 nt
    v_add_f32_dpp v26, v18, v18 row_mirror row_mask:0xf bank_mask:0x3
    v_add_f32_dpp v27, v19, v19 row_mirror row_mask:0xf bank_mask:0x3
    v_add_f32_dpp v28, v20, v20 row_mirror row_mask:0xf bank_mask:0x3
    v_add_f32_dpp v29, v21, v21 row_mirror row_mask:0xf bank_mask:0x3
    v_add_f32_dpp v26, v22, v22 row_mirror row_mask:0xf bank_mask:0xc
    v_add_f32_dpp v27, v23, v23 row_mirror row_mask:0xf bank_mask:0xc
    v_add_f32_dpp v28, v24, v24 row_mirror row_mask:0xf bank_mask:0xc
    v_add_f32_dpp v29, v25, v25 row_mirror row_mask:0xf bank_mask:0xc
    v_add_f32_dpp v30, v26, v26 row_half_mirror row_mask:0xf bank_mask:0x5
    v_add_f32_dpp v31, v27, v27 row_half_mirror row_mask:0xf bank_mask:0x5
    s_nop 0
    v_add_f32_dpp v30, v28, v28 row_half_mirror row_mask:0xf bank_mask:0xa
    v_add_f32_dpp v31, v29, v29 row_half_mirror row_mask:0xf bank_mask:0xa
    s_nop 0
    v_add_f32_dpp v30, v30, v30 quad_perm:[1,0,3,2] row_mask:0xf bank_mask:0xf
    v_add_f32_dpp v31, v31, v31 quad_perm:[1,0,3,2] row_mask:0xf bank_mask:0xf
    s_nop 0
    v_add_f32_dpp v30, v30, v30 quad_perm:[2,3,0,1] row_mask:0xf bank_mask:0xf
    v_add_f32_dpp v31, v31, v31 quad_perm:[2,3,0,1] row_mask:0xf bank_mask:0xf
    v_cvt_pk_bf16_f32 v42, v30, v31
    v_lshlrev_b32 v40, 16, v42
    v_and_b32 v41, s68, v42
    v_mul_f32 v40, s11, v40
    v_mul_f32 v41, s11, v41
    v_cvt_pk_bf16_f32 v42, v40, v41
    v_lshlrev_b32 v40, 16, v42
    v_and_b32 v41, s68, v42
    ds_write_b32 v62, v42 offset:16384
    v_max3_f32 v16, v16, v40, v41
    s_waitcnt vmcnt(4)
    v_dot2_f32_bf16 v18, v96, v8, 0
    v_dot2_f32_bf16 v18, v97, v9, v18
    v_dot2_f32_bf16 v18, v98, v10, v18
    v_dot2_f32_bf16 v18, v99, v11, v18
    buffer_load_dwordx4 v[116:119], v3, s[44:47], s69 offen offset:1024 nt
    s_waitcnt vmcnt(4)
    v_dot2_f32_bf16 v19, v100, v8, 0
    v_dot2_f32_bf16 v19, v101, v9, v19
    v_dot2_f32_bf16 v19, v102, v10, v19
    v_dot2_f32_bf16 v19, v103, v11, v19
    buffer_load_dwordx4 v[120:123], v3, s[44:47], s69 offen offset:2048 nt
    s_waitcnt vmcnt(4)
    v_dot2_f32_bf16 v20, v104, v8, 0
    v_dot2_f32_bf16 v20, v105, v9, v20
    v_dot2_f32_bf16 v20, v106, v10, v20
    v_dot2_f32_bf16 v20, v107, v11, v20
    buffer_load_dwordx4 v[124:127], v3, s[44:47], s69 offen offset:3072 nt
    s_waitcnt vmcnt(4)
    v_dot2_f32_bf16 v21, v108, v8, 0
    v_dot2_f32_bf16 v21, v109, v9, v21
    v_dot2_f32_bf16 v21, v110, v10, v21
    v_dot2_f32_bf16 v21, v111, v11, v21
    s_add_u32 s8, s89, 983040
    s_and_b32 s8, s8, 0xfffff
    buffer_load_dwordx4 v[64:67], v2, s[44:47], s8 offen offset:0 nt
    s_waitcnt vmcnt(4)
    v_dot2_f32_bf16 v22, v112, v8, 0
    v_dot2_f32_bf16 v22, v113, v9, v22
    v_dot2_f32_bf16 v22, v114, v10, v22
    v_dot2_f32_bf16 v22, v115, v11, v22
    buffer_load_dwordx4 v[68:71], v2, s[44:47], s8 offen offset:1024 nt
    s_waitcnt vmcnt(4)
    v_dot2_f32_bf16 v23, v116, v8, 0
    v_dot2_f32_bf16 v23, v117, v9, v23
    v_dot2_f32_bf16 v23, v118, v10, v23
    v_dot2_f32_bf16 v23, v119, v11, v23
    buffer_load_dwordx4 v[72:75], v2, s[44:47], s8 offen offset:2048 nt
    s_waitcnt vmcnt(4)
    v_dot2_f32_bf16 v24, v120, v8, 0
    v_dot2_f32_bf16 v24, v121, v9, v24
    v_dot2_f32_bf16 v24, v122, v10, v24
    v_dot2_f32_bf16 v24, v123, v11, v24
    buffer_load_dwordx4 v[76:79], v2, s[44:47], s8 offen offset:3072 nt
    s_waitcnt vmcnt(4)
    v_dot2_f32_bf16 v25, v124, v8, 0
    v_dot2_f32_bf16 v25, v125, v9, v25
    v_dot2_f32_bf16 v25, v126, v10, v25
    v_dot2_f32_bf16 v25, v127, v11, v25
    buffer_load_dwordx4 v[80:83], v3, s[44:47], s8 offen offset:0 nt
    v_add_f32_dpp v26, v18, v18 row_mirror row_mask:0xf bank_mask:0x3
    v_add_f32_dpp v27, v19, v19 row_mirror row_mask:0xf bank_mask:0x3
    v_add_f32_dpp v28, v20, v20 row_mirror row_mask:0xf bank_mask:0x3
    v_add_f32_dpp v29, v21, v21 row_mirror row_mask:0xf bank_mask:0x3
    v_add_f32_dpp v26, v22, v22 row_mirror row_mask:0xf bank_mask:0xc
    v_add_f32_dpp v27, v23, v23 row_mirror row_mask:0xf bank_mask:0xc
    v_add_f32_dpp v28, v24, v24 row_mirror row_mask:0xf bank_mask:0xc
    v_add_f32_dpp v29, v25, v25 row_mirror row_mask:0xf bank_mask:0xc
    v_add_f32_dpp v30, v26, v26 row_half_mirror row_mask:0xf bank_mask:0x5
    v_add_f32_dpp v31, v27, v27 row_half_mirror row_mask:0xf bank_mask:0x5
    s_nop 0
    v_add_f32_dpp v30, v28, v28 row_half_mirror row_mask:0xf bank_mask:0xa
    v_add_f32_dpp v31, v29, v29 row_half_mirror row_mask:0xf bank_mask:0xa
    s_nop 0
    v_add_f32_dpp v30, v30, v30 quad_perm:[1,0,3,2] row_mask:0xf bank_mask:0xf
    v_add_f32_dpp v31, v31, v31 quad_perm:[1,0,3,2] row_mask:0xf bank_mask:0xf
    s_nop 0
    v_add_f32_dpp v30, v30, v30 quad_perm:[2,3,0,1] row_mask:0xf bank_mask:0xf
    v_add_f32_dpp v31, v31, v31 quad_perm:[2,3,0,1] row_mask:0xf bank_mask:0xf
    v_cvt_pk_bf16_f32 v42, v30, v31
    v_lshlrev_b32 v40, 16, v42
    v_and_b32 v41, s68, v42
    v_mul_f32 v40, s11, v40
    v_mul_f32 v41, s11, v41
    v_cvt_pk_bf16_f32 v42, v40, v41
    v_lshlrev_b32 v40, 16, v42
    v_and_b32 v41, s68, v42
    ds_write_b32 v62, v42 offset:16640
    v_max3_f32 v16, v16, v40, v41
    v_add_u32 v62, 512, v62
    s_waitcnt vmcnt(4)
    v_dot2_f32_bf16 v18, v64, v8, 0
    v_dot2_f32_bf16 v18, v65, v9, v18
    v_dot2_f32_bf16 v18, v66, v10, v18
    v_dot2_f32_bf16 v18, v67, v11, v18
    buffer_load_dwordx4 v[84:87], v3, s[44:47], s8 offen offset:1024 nt
    s_waitcnt vmcnt(4)
    v_dot2_f32_bf16 v19, v68, v8, 0
    v_dot2_f32_bf16 v19, v69, v9, v19
    v_dot2_f32_bf16 v19, v70, v10, v19
    v_dot2_f32_bf16 v19, v71, v11, v19
    buffer_load_dwordx4 v[88:91], v3, s[44:47], s8 offen offset:2048 nt
    s_waitcnt vmcnt(4)
    v_dot2_f32_bf16 v20, v72, v8, 0
    v_dot2_f32_bf16 v20, v73, v9, v20
    v_dot2_f32_bf16 v20, v74, v10, v20
    v_dot2_f32_bf16 v20, v75, v11, v20
    buffer_load_dwordx4 v[92:95], v3, s[44:47], s8 offen offset:3072 nt
    s_waitcnt vmcnt(4)
    v_dot2_f32_bf16 v21, v76, v8, 0
    v_dot2_f32_bf16 v21, v77, v9, v21
    v_dot2_f32_bf16 v21, v78, v10, v21
    v_dot2_f32_bf16 v21, v79, v11, v21
    s_add_u32 s69, s89, 1015808
    s_and_b32 s69, s69, 0xfffff
    buffer_load_dwordx4 v[96:99], v2, s[44:47], s69 offen offset:0 nt
    s_waitcnt vmcnt(4)
    v_dot2_f32_bf16 v22, v80, v8, 0
    v_dot2_f32_bf16 v22, v81, v9, v22
    v_dot2_f32_bf16 v22, v82, v10, v22
    v_dot2_f32_bf16 v22, v83, v11, v22
    buffer_load_dwordx4 v[100:103], v2, s[44:47], s69 offen offset:1024 nt
    s_waitcnt vmcnt(4)
    v_dot2_f32_bf16 v23, v84, v8, 0
    v_dot2_f32_bf16 v23, v85, v9, v23
    v_dot2_f32_bf16 v23, v86, v10, v23
    v_dot2_f32_bf16 v23, v87, v11, v23
    buffer_load_dwordx4 v[104:107], v2, s[44:47], s69 offen offset:2048 nt
    s_waitcnt vmcnt(4)
    v_dot2_f32_bf16 v24, v88, v8, 0
    v_dot2_f32_bf16 v24, v89, v9, v24
    v_dot2_f32_bf16 v24, v90, v10, v24
    v_dot2_f32_bf16 v24, v91, v11, v24
    buffer_load_dwordx4 v[108:111], v2, s[44:47], s69 offen offset:3072 nt
    s_waitcnt vmcnt(4)
    v_dot2_f32_bf16 v25, v92, v8, 0
    v_dot2_f32_bf16 v25, v93, v9, v25
    v_dot2_f32_bf16 v25, v94, v10, v25
    v_dot2_f32_bf16 v25, v95, v11, v25
    buffer_load_dwordx4 v[112:115], v3, s[44:47], s69 offen offset:0 nt
    v_add_f32_dpp v26, v18, v18 row_mirror row_mask:0xf bank_mask:0x3
    v_add_f32_dpp v27, v19, v19 row_mirror row_mask:0xf bank_mask:0x3
    v_add_f32_dpp v28, v20, v20 row_mirror row_mask:0xf bank_mask:0x3
    v_add_f32_dpp v29, v21, v21 row_mirror row_mask:0xf bank_mask:0x3
    v_add_f32_dpp v26, v22, v22 row_mirror row_mask:0xf bank_mask:0xc
    v_add_f32_dpp v27, v23, v23 row_mirror row_mask:0xf bank_mask:0xc
    v_add_f32_dpp v28, v24, v24 row_mirror row_mask:0xf bank_mask:0xc
    v_add_f32_dpp v29, v25, v25 row_mirror row_mask:0xf bank_mask:0xc
    v_add_f32_dpp v30, v26, v26 row_half_mirror row_mask:0xf bank_mask:0x5
    v_add_f32_dpp v31, v27, v27 row_half_mirror row_mask:0xf bank_mask:0x5
    s_nop 0
    v_add_f32_dpp v30, v28, v28 row_half_mirror row_mask:0xf bank_mask:0xa
    v_add_f32_dpp v31, v29, v29 row_half_mirror row_mask:0xf bank_mask:0xa
    s_nop 0
    v_add_f32_dpp v30, v30, v30 quad_perm:[1,0,3,2] row_mask:0xf bank_mask:0xf
    v_add_f32_dpp v31, v31, v31 quad_perm:[1,0,3,2] row_mask:0xf bank_mask:0xf
    s_nop 0
    v_add_f32_dpp v30, v30, v30 quad_perm:[2,3,0,1] row_mask:0xf bank_mask:0xf
    v_add_f32_dpp v31, v31, v31 quad_perm:[2,3,0,1] row_mask:0xf bank_mask:0xf
    v_cvt_pk_bf16_f32 v42, v30, v31
    v_lshlrev_b32 v40, 16, v42
    v_and_b32 v41, s68, v42
    v_mul_f32 v40, s11, v40
    v_mul_f32 v41, s11, v41
    v_cvt_pk_bf16_f32 v42, v40, v41
    v_lshlrev_b32 v40, 16, v42
    v_and_b32 v41, s68, v42
    ds_write_b32 v62, v42 offset:16384
    v_max3_f32 v16, v16, v40, v41
    s_waitcnt vmcnt(4)
    v_dot2_f32_bf16 v18, v96, v8, 0
    v_dot2_f32_bf16 v18, v97, v9, v18
    v_dot2_f32_bf16 v18, v98, v10, v18
    v_dot2_f32_bf16 v18, v99, v11, v18
    buffer_load_dwordx4 v[116:119], v3, s[44:47], s69 offen offset:1024 nt
    s_waitcnt vmcnt(4)
    v_dot2_f32_bf16 v19, v100, v8, 0
    v_dot2_f32_bf16 v19, v101, v9, v19
    v_dot2_f32_bf16 v19, v102, v10, v19
    v_dot2_f32_bf16 v19, v103, v11, v19
    buffer_load_dwordx4 v[120:123], v3, s[44:47], s69 offen offset:2048 nt
    s_waitcnt vmcnt(4)
    v_dot2_f32_bf16 v20, v104, v8, 0
    v_dot2_f32_bf16 v20, v105, v9, v20
    v_dot2_f32_bf16 v20, v106, v10, v20
    v_dot2_f32_bf16 v20, v107, v11, v20
    buffer_load_dwordx4 v[124:127], v3, s[44:47], s69 offen offset:3072 nt
    s_waitcnt vmcnt(4)
    v_dot2_f32_bf16 v21, v108, v8, 0
    v_dot2_f32_bf16 v21, v109, v9, v21
    v_dot2_f32_bf16 v21, v110, v10, v21
    v_dot2_f32_bf16 v21, v111, v11, v21
    s_add_u32 s8, s89, 0
    s_and_b32 s8, s8, 0xfffff
    buffer_load_dwordx4 v[64:67], v2, s[48:51], s8 offen offset:0 nt
    s_waitcnt vmcnt(4)
    v_dot2_f32_bf16 v22, v112, v8, 0
    v_dot2_f32_bf16 v22, v113, v9, v22
    v_dot2_f32_bf16 v22, v114, v10, v22
    v_dot2_f32_bf16 v22, v115, v11, v22
    buffer_load_dwordx4 v[68:71], v2, s[48:51], s8 offen offset:1024 nt
    s_waitcnt vmcnt(4)
    v_dot2_f32_bf16 v23, v116, v8, 0
    v_dot2_f32_bf16 v23, v117, v9, v23
    v_dot2_f32_bf16 v23, v118, v10, v23
    v_dot2_f32_bf16 v23, v119, v11, v23
    buffer_load_dwordx4 v[72:75], v2, s[48:51], s8 offen offset:2048 nt
    s_waitcnt vmcnt(4)
    v_dot2_f32_bf16 v24, v120, v8, 0
    v_dot2_f32_bf16 v24, v121, v9, v24
    v_dot2_f32_bf16 v24, v122, v10, v24
    v_dot2_f32_bf16 v24, v123, v11, v24
    buffer_load_dwordx4 v[76:79], v2, s[48:51], s8 offen offset:3072 nt
    s_waitcnt vmcnt(4)
    v_dot2_f32_bf16 v25, v124, v8, 0
    v_dot2_f32_bf16 v25, v125, v9, v25
    v_dot2_f32_bf16 v25, v126, v10, v25
    v_dot2_f32_bf16 v25, v127, v11, v25
    buffer_load_dwordx4 v[80:83], v3, s[48:51], s8 offen offset:0 nt
    v_add_f32_dpp v26, v18, v18 row_mirror row_mask:0xf bank_mask:0x3
    v_add_f32_dpp v27, v19, v19 row_mirror row_mask:0xf bank_mask:0x3
    v_add_f32_dpp v28, v20, v20 row_mirror row_mask:0xf bank_mask:0x3
    v_add_f32_dpp v29, v21, v21 row_mirror row_mask:0xf bank_mask:0x3
    v_add_f32_dpp v26, v22, v22 row_mirror row_mask:0xf bank_mask:0xc
    v_add_f32_dpp v27, v23, v23 row_mirror row_mask:0xf bank_mask:0xc
    v_add_f32_dpp v28, v24, v24 row_mirror row_mask:0xf bank_mask:0xc
    v_add_f32_dpp v29, v25, v25 row_mirror row_mask:0xf bank_mask:0xc
    v_add_f32_dpp v30, v26, v26 row_half_mirror row_mask:0xf bank_mask:0x5
    v_add_f32_dpp v31, v27, v27 row_half_mirror row_mask:0xf bank_mask:0x5
    s_nop 0
    v_add_f32_dpp v30, v28, v28 row_half_mirror row_mask:0xf bank_mask:0xa
    v_add_f32_dpp v31, v29, v29 row_half_mirror row_mask:0xf bank_mask:0xa
    s_nop 0
    v_add_f32_dpp v30, v30, v30 quad_perm:[1,0,3,2] row_mask:0xf bank_mask:0xf
    v_add_f32_dpp v31, v31, v31 quad_perm:[1,0,3,2] row_mask:0xf bank_mask:0xf
    s_nop 0
    v_add_f32_dpp v30, v30, v30 quad_perm:[2,3,0,1] row_mask:0xf bank_mask:0xf
    v_add_f32_dpp v31, v31, v31 quad_perm:[2,3,0,1] row_mask:0xf bank_mask:0xf
    v_cvt_pk_bf16_f32 v42, v30, v31
    v_lshlrev_b32 v40, 16, v42
    v_and_b32 v41, s68, v42
    v_mul_f32 v40, s11, v40
    v_mul_f32 v41, s11, v41
    v_cvt_pk_bf16_f32 v42, v40, v41
    v_lshlrev_b32 v40, 16, v42
    v_and_b32 v41, s68, v42
    ds_write_b32 v62, v42 offset:16640
    v_max3_f32 v16, v16, v40, v41
    v_add_u32 v62, 512, v62
    s_lshl_b32 s14, s3, 13
    v_lshlrev_b32 v62, 2, v1
    v_add_u32 v62, s14, v62
    v_max_f32_dpp v16, v16, v16 row_half_mirror row_mask:0xf bank_mask:0xf
    s_waitcnt lgkmcnt(0)
    ds_read_b32 v60, v62 offset:16384
    ds_read_b32 v61, v62 offset:16640
    v_max_f32_dpp v16, v16, v16 row_mirror row_mask:0xf bank_mask:0xf
    s_nop 1
    v_max_f32_dpp v16, v16, v16 row_bcast:15 row_mask:0xa bank_mask:0xf
    s_nop 1
    v_max_f32_dpp v16, v16, v16 row_bcast:31 row_mask:0xc bank_mask:0xf
    s_nop 0
    v_readlane_b32 s14, v16, 63
    s_nop 1
    v_mov_b32 v16, s14
    v_mul_f32 v44, s10, v16
    v_add_u32 v62, 512, v62
    s_waitcnt lgkmcnt(0)
    s_add_u32 s8, s89, 0
    s_and_b32 s8, s8, 0xfffff
    s_add_u32 s69, s89, 32768
    s_and_b32 s69, s69, 0xfffff
    s_mov_b32 s9, 12
L_vloop:
    v_lshlrev_b32 v40, 16, v60
    v_and_b32 v41, s68, v60
    ds_read_b32 v60, v62 offset:16384
    v_fma_f32 v46, v40, s10, -v44
    v_fma_f32 v47, v41, s10, -v44
    v_exp_f32 v46, v46
    v_exp_f32 v47, v47
    v_add_f32 v17, v17, v46
    v_cvt_pk_bf16_f32 v40, v46, v46
    v_cvt_pk_bf16_f32 v41, v47, v47
    v_add_f32 v17, v17, v47
    v_and_b32_dpp v32, v40, v4 row_newbcast:0 row_mask:0xf bank_mask:0xf
    v_and_b32_dpp v33, v40, v5 row_newbcast:0 row_mask:0xf bank_mask:0xf
    v_and_b32_dpp v34, v40, v6 row_newbcast:0 row_mask:0xf bank_mask:0xf
    v_and_b32_dpp v35, v40, v7 row_newbcast:0 row_mask:0xf bank_mask:0xf
    v_and_b32_dpp v36, v41, v4 row_newbcast:0 row_mask:0xf bank_mask:0xf
    v_and_b32_dpp v37, v41, v5 row_newbcast:0 row_mask:0xf bank_mask:0xf
    v_and_b32_dpp v38, v41, v6 row_newbcast:0 row_mask:0xf bank_mask:0xf
    v_and_b32_dpp v39, v41, v7 row_newbcast:0 row_mask:0xf bank_mask:0xf
    s_waitcnt vmcnt(4)
    v_mfma_f32_16x16x32_bf16 v[12:15], v[32:35], v[64:67], v[12:15]
    buffer_load_dwordx4 v[84:87], v3, s[48:51], s8 offen offset:1024 nt
    v_and_b32_dpp v32, v40, v4 row_newbcast:4 row_mask:0xf bank_mask:0xf
    v_and_b32_dpp v33, v40, v5 row_newbcast:4 row_mask:0xf bank_mask:0xf
    v_and_b32_dpp v34, v40, v6 row_newbcast:4 row_mask:0xf bank_mask:0xf
    v_and_b32_dpp v35, v40, v7 row_newbcast:4 row_mask:0xf bank_mask:0xf
    s_waitcnt vmcnt(4)
    v_mfma_f32_16x16x32_bf16 v[12:15], v[36:39], v[68:71], v[12:15]
    buffer_load_dwordx4 v[88:91], v3, s[48:51], s8 offen offset:2048 nt
    v_and_b32_dpp v36, v41, v4 row_newbcast:4 row_mask:0xf bank_mask:0xf
    v_and_b32_dpp v37, v41, v5 row_newbcast:4 row_mask:0xf bank_mask:0xf
    v_and_b32_dpp v38, v41, v6 row_newbcast:4 row_mask:0xf bank_mask:0xf
    v_and_b32_dpp v39, v41, v7 row_newbcast:4 row_mask:0xf bank_mask:0xf
    s_waitcnt vmcnt(4)
    v_mfma_f32_16x16x32_bf16 v[12:15], v[32:35], v[72:75], v[12:15]
    buffer_load_dwordx4 v[92:95], v3, s[48:51], s8 offen offset:3072 nt
    v_and_b32_dpp v32, v40, v4 row_newbcast:8 row_mask:0xf bank_mask:0xf
    v_and_b32_dpp v33, v40, v5 row_newbcast:8 row_mask:0xf bank_mask:0xf
    v_and_b32_dpp v34, v40, v6 row_newbcast:8 row_mask:0xf bank_mask:0xf
    v_and_b32_dpp v35, v40, v7 row_newbcast:8 row_mask:0xf bank_mask:0xf
    s_waitcnt vmcnt(4)
    v_mfma_f32_16x16x32_bf16 v[12:15], v[36:39], v[76:79], v[12:15]
    buffer_load_dwordx4 v[96:99], v2, s[48:51], s69 offen offset:0 nt
    v_and_b32_dpp v36, v41, v4 row_newbcast:8 row_mask:0xf bank_mask:0xf
    v_and_b32_dpp v37, v41, v5 row_newbcast:8 row_mask:0xf bank_mask:0xf
    v_and_b32_dpp v38, v41, v6 row_newbcast:8 row_mask:0xf bank_mask:0xf
    v_and_b32_dpp v39, v41, v7 row_newbcast:8 row_mask:0xf bank_mask:0xf
    s_waitcnt vmcnt(4)
    v_mfma_f32_16x16x32_bf16 v[12:15], v[32:35], v[80:83], v[12:15]
    buffer_load_dwordx4 v[100:103], v2, s[48:51], s69 offen offset:1024 nt
    v_and_b32_dpp v32, v40, v4 row_newbcast:12 row_mask:0xf bank_mask:0xf
    v_and_b32_dpp v33, v40, v5 row_newbcast:12 row_mask:0xf bank_mask:0xf
    v_and_b32_dpp v34, v40, v6 row_newbcast:12 row_mask:0xf bank_mask:0xf
    v_and_b32_dpp v35, v40, v7 row_newbcast:12 row_mask:0xf bank_mask:0xf
    s_waitcnt vmcnt(4)
    v_mfma_f32_16x16x32_bf16 v[12:15], v[36:39], v[84:87], v[12:15]
    buffer_load_dwordx4 v[104:107], v2, s[48:51], s69 offen offset:2048 nt
    v_and_b32_dpp v36, v41, v4 row_newbcast:12 row_mask:0xf bank_mask:0xf
    v_and_b32_dpp v37, v41, v5 row_newbcast:12 row_mask:0xf bank_mask:0xf
    v_and_b32_dpp v38, v41, v6 row_newbcast:12 row_mask:0xf bank_mask:0xf
    v_and_b32_dpp v39, v41, v7 row_newbcast:12 row_mask:0xf bank_mask:0xf
    s_waitcnt vmcnt(4)
    v_mfma_f32_16x16x32_bf16 v[12:15], v[32:35], v[88:91], v[12:15]
    buffer_load_dwordx4 v[108:111], v2, s[48:51], s69 offen offset:3072 nt
    s_waitcnt vmcnt(4)
    v_mfma_f32_16x16x32_bf16 v[12:15], v[36:39], v[92:95], v[12:15]
    buffer_load_dwordx4 v[112:115], v3, s[48:51], s69 offen offset:0 nt
    s_mov_b32 s8, s69
    s_add_u32 s69, s69, 32768
    s_and_b32 s69, s69, 0xfffff
    v_lshlrev_b32 v40, 16, v61
    v_and_b32 v41, s68, v61
    ds_read_b32 v61, v62 offset:16640
    v_fma_f32 v46, v40, s10, -v44
    v_fma_f32 v47, v41, s10, -v44
    v_exp_f32 v46, v46
    v_exp_f32 v47, v47
    v_add_f32 v17, v17, v46
    v_cvt_pk_bf16_f32 v40, v46, v46
    v_cvt_pk_bf16_f32 v41, v47, v47
    v_add_f32 v17, v17, v47
    v_and_b32_dpp v32, v40, v4 row_newbcast:0 row_mask:0xf bank_mask:0xf
    v_and_b32_dpp v33, v40, v5 row_newbcast:0 row_mask:0xf bank_mask:0xf
    v_and_b32_dpp v34, v40, v6 row_newbcast:0 row_mask:0xf bank_mask:0xf
    v_and_b32_dpp v35, v40, v7 row_newbcast:0 row_mask:0xf bank_mask:0xf
    v_and_b32_dpp v36, v41, v4 row_newbcast:0 row_mask:0xf bank_mask:0xf
    v_and_b32_dpp v37, v41, v5 row_newbcast:0 row_mask:0xf bank_mask:0xf
    v_and_b32_dpp v38, v41, v6 row_newbcast:0 row_mask:0xf bank_mask:0xf
    v_and_b32_dpp v39, v41, v7 row_newbcast:0 row_mask:0xf bank_mask:0xf
    s_waitcnt vmcnt(4)
    v_mfma_f32_16x16x32_bf16 v[12:15], v[32:35], v[96:99], v[12:15]
    buffer_load_dwordx4 v[116:119], v3, s[48:51], s8 offen offset:1024 nt
    v_and_b32_dpp v32, v40, v4 row_newbcast:4 row_mask:0xf bank_mask:0xf
    v_and_b32_dpp v33, v40, v5 row_newbcast:4 row_mask:0xf bank_mask:0xf
    v_and_b32_dpp v34, v40, v6 row_newbcast:4 row_mask:0xf bank_mask:0xf
    v_and_b32_dpp v35, v40, v7 row_newbcast:4 row_mask:0xf bank_mask:0xf
    s_waitcnt vmcnt(4)
    v_mfma_f32_16x16x32_bf16 v[12:15], v[36:39], v[100:103], v[12:15]
    buffer_load_dwordx4 v[120:123], v3, s[48:51], s8 offen offset:2048 nt
    v_and_b32_dpp v36, v41, v4 row_newbcast:4 row_mask:0xf bank_mask:0xf
    v_and_b32_dpp v37, v41, v5 row_newbcast:4 row_mask:0xf bank_mask:0xf
    v_and_b32_dpp v38, v41, v6 row_newbcast:4 row_mask:0xf bank_mask:0xf
    v_and_b32_dpp v39, v41, v7 row_newbcast:4 row_mask:0xf bank_mask:0xf
    s_waitcnt vmcnt(4)
    v_mfma_f32_16x16x32_bf16 v[12:15], v[32:35], v[104:107], v[12:15]
    buffer_load_dwordx4 v[124:127], v3, s[48:51], s8 offen offset:3072 nt
    v_and_b32_dpp v32, v40, v4 row_newbcast:8 row_mask:0xf bank_mask:0xf
    v_and_b32_dpp v33, v40, v5 row_newbcast:8 row_mask:0xf bank_mask:0xf
    v_and_b32_dpp v34, v40, v6 row_newbcast:8 row_mask:0xf bank_mask:0xf
    v_and_b32_dpp v35, v40, v7 row_newbcast:8 row_mask:0xf bank_mask:0xf
    s_waitcnt vmcnt(4)
    v_mfma_f32_16x16x32_bf16 v[12:15], v[36:39], v[108:111], v[12:15]
    buffer_load_dwordx4 v[64:67], v2, s[48:51], s69 offen offset:0 nt
    v_and_b32_dpp v36, v41, v4 row_newbcast:8 row_mask:0xf bank_mask:0xf
    v_and_b32_dpp v37, v41, v5 row_newbcast:8 row_mask:0xf bank_mask:0xf
    v_and_b32_dpp v38, v41, v6 row_newbcast:8 row_mask:0xf bank_mask:0xf
    v_and_b32_dpp v39, v41, v7 row_newbcast:8 row_mask:0xf bank_mask:0xf
    s_waitcnt vmcnt(4)
    v_mfma_f32_16x16x32_bf16 v[12:15], v[32:35], v[112:115], v[12:15]
    buffer_load_dwordx4 v[68:71], v2, s[48:51], s69 offen offset:1024 nt
    v_and_b32_dpp v32, v40, v4 row_newbcast:12 row_mask:0xf bank_mask:0xf
    v_and_b32_dpp v33, v40, v5 row_newbcast:12 row_mask:0xf bank_mask:0xf
    v_and_b32_dpp v34, v40, v6 row_newbcast:12 row_mask:0xf bank_mask:0xf
    v_and_b32_dpp v35, v40, v7 row_newbcast:12 row_mask:0xf bank_mask:0xf
    s_waitcnt vmcnt(4)
    v_mfma_f32_16x16x32_bf16 v[12:15], v[36:39], v[116:119], v[12:15]
    buffer_load_dwordx4 v[72:75], v2, s[48:51], s69 offen offset:2048 nt
    v_and_b32_dpp v36, v41, v4 row_newbcast:12 row_mask:0xf bank_mask:0xf
    v_and_b32_dpp v37, v41, v5 row_newbcast:12 row_mask:0xf bank_mask:0xf
    v_and_b32_dpp v38, v41, v6 row_newbcast:12 row_mask:0xf bank_mask:0xf
    v_and_b32_dpp v39, v41, v7 row_newbcast:12 row_mask:0xf bank_mask:0xf
    s_waitcnt vmcnt(4)
    v_mfma_f32_16x16x32_bf16 v[12:15], v[32:35], v[120:123], v[12:15]
    buffer_load_dwordx4 v[76:79], v2, s[48:51], s69 offen offset:3072 nt
    s_waitcnt vmcnt(4)
    v_mfma_f32_16x16x32_bf16 v[12:15], v[36:39], v[124:127], v[12:15]
    buffer_load_dwordx4 v[80:83], v3, s[48:51], s69 offen offset:0 nt
    s_mov_b32 s8, s69
    s_add_u32 s69, s69, 32768
    s_and_b32 s69, s69, 0xfffff
    v_add_u32 v62, 512, v62
    s_sub_u32 s9, s9, 1
    s_cmp_lg_u32 s9, 0
    s_waitcnt lgkmcnt(0)
    s_cbranch_scc1 L_vloop
    v_lshlrev_b32 v40, 16, v60
    v_and_b32 v41, s68, v60
    ds_read_b32 v60, v62 offset:16384
    v_fma_f32 v46, v40, s10, -v44
    v_fma_f32 v47, v41, s10, -v44
    v_exp_f32 v46, v46
    v_exp_f32 v47, v47
    v_add_f32 v17, v17, v46
    v_cvt_pk_bf16_f32 v40, v46, v46
    v_cvt_pk_bf16_f32 v41, v47, v47
    v_add_f32 v17, v17, v47
    v_and_b32_dpp v32, v40, v4 row_newbcast:0 row_mask:0xf bank_mask:0xf
    v_and_b32_dpp v33, v40, v5 row_newbcast:0 row_mask:0xf bank_mask:0xf
    v_and_b32_dpp v34, v40, v6 row_newbcast:0 row_mask:0xf bank_mask:0xf
    v_and_b32_dpp v35, v40, v7 row_newbcast:0 row_mask:0xf bank_mask:0xf
    v_and_b32_dpp v36, v41, v4 row_newbcast:0 row_mask:0xf bank_mask:0xf
    v_and_b32_dpp v37, v41, v5 row_newbcast:0 row_mask:0xf bank_mask:0xf
    v_and_b32_dpp v38, v41, v6 row_newbcast:0 row_mask:0xf bank_mask:0xf
    v_and_b32_dpp v39, v41, v7 row_newbcast:0 row_mask:0xf bank_mask:0xf
    s_waitcnt vmcnt(4)
    v_mfma_f32_16x16x32_bf16 v[12:15], v[32:35], v[64:67], v[12:15]
    s_add_u32 s8, s89, 786432
    s_and_b32 s8, s8, 0xfffff
    buffer_load_dwordx4 v[84:87], v3, s[48:51], s8 offen offset:1024 nt
    buffer_load_dwordx4 v[88:91], v3, s[48:51], s8 offen offset:2048 nt
    buffer_load_dwordx4 v[92:95], v3, s[48:51], s8 offen offset:3072 nt
    v_and_b32_dpp v32, v40, v4 row_newbcast:4 row_mask:0xf bank_mask:0xf
    v_and_b32_dpp v33, v40, v5 row_newbcast:4 row_mask:0xf bank_mask:0xf
    v_and_b32_dpp v34, v40, v6 row_newbcast:4 row_mask:0xf bank_mask:0xf
    v_and_b32_dpp v35, v40, v7 row_newbcast:4 row_mask:0xf bank_mask:0xf
    s_waitcnt vmcnt(6)
    v_mfma_f32_16x16x32_bf16 v[12:15], v[36:39], v[68:71], v[12:15]
    s_add_u32 s69, s89, 819200
    s_and_b32 s69, s69, 0xfffff
    buffer_load_dwordx4 v[96:99], v2, s[48:51], s69 offen offset:0 nt
    buffer_load_dwordx4 v[100:103], v2, s[48:51], s69 offen offset:1024 nt
    buffer_load_dwordx4 v[104:107], v2, s[48:51], s69 offen offset:2048 nt
    v_and_b32_dpp v36, v41, v4 row_newbcast:4 row_mask:0xf bank_mask:0xf
    v_and_b32_dpp v37, v41, v5 row_newbcast:4 row_mask:0xf bank_mask:0xf
    v_and_b32_dpp v38, v41, v6 row_newbcast:4 row_mask:0xf bank_mask:0xf
    v_and_b32_dpp v39, v41, v7 row_newbcast:4 row_mask:0xf bank_mask:0xf
    s_waitcnt vmcnt(8)
    v_mfma_f32_16x16x32_bf16 v[12:15], v[32:35], v[72:75], v[12:15]
    buffer_load_dwordx4 v[108:111], v2, s[48:51], s69 offen offset:3072 nt
    buffer_load_dwordx4 v[112:115], v3, s[48:51], s69 offen offset:0 nt
    buffer_load_dwordx4 v[116:119], v3, s[48:51], s69 offen offset:1024 nt
    v_and_b32_dpp v32, v40, v4 row_newbcast:8 row_mask:0xf bank_mask:0xf
    v_and_b32_dpp v33, v40, v5 row_newbcast:8 row_mask:0xf bank_mask:0xf
    v_and_b32_dpp v34, v40, v6 row_newbcast:8 row_mask:0xf bank_mask:0xf
    v_and_b32_dpp v35, v40, v7 row_newbcast:8 row_mask:0xf bank_mask:0xf
    s_waitcnt vmcnt(10)
    v_mfma_f32_16x16x32_bf16 v[12:15], v[36:39], v[76:79], v[12:15]
    buffer_load_dwordx4 v[120:123], v3, s[48:51], s69 offen offset:2048 nt
    buffer_load_dwordx4 v[124:127], v3, s[48:51], s69 offen offset:3072 nt
    s_add_u32 s8, s89, 851968
    s_and_b32 s8, s8, 0xfffff
    buffer_load_dwordx4 v[64:67], v2, s[48:51], s8 offen offset:0 nt
    v_and_b32_dpp v36, v41, v4 row_newbcast:8 row_mask:0xf bank_mask:0xf
    v_and_b32_dpp v37, v41, v5 row_newbcast:8 row_mask:0xf bank_mask:0xf
    v_and_b32_dpp v38, v41, v6 row_newbcast:8 row_mask:0xf bank_mask:0xf
    v_and_b32_dpp v39, v41, v7 row_newbcast:8 row_mask:0xf bank_mask:0xf
    s_waitcnt vmcnt(12)
    v_mfma_f32_16x16x32_bf16 v[12:15], v[32:35], v[80:83], v[12:15]
    buffer_load_dwordx4 v[68:71], v2, s[48:51], s8 offen offset:1024 nt
    buffer_load_dwordx4 v[72:75], v2, s[48:51], s8 offen offset:2048 nt
    buffer_load_dwordx4 v[76:79], v2, s[48:51], s8 offen offset:3072 nt
    v_and_b32_dpp v32, v40, v4 row_newbcast:12 row_mask:0xf bank_mask:0xf
    v_and_b32_dpp v33, v40, v5 row_newbcast:12 row_mask:0xf bank_mask:0xf
    v_and_b32_dpp v34, v40, v6 row_newbcast:12 row_mask:0xf bank_mask:0xf
    v_and_b32_dpp v35, v40, v7 row_newbcast:12 row_mask:0xf bank_mask:0xf
    s_waitcnt vmcnt(14)
    v_mfma_f32_16x16x32_bf16 v[12:15], v[36:39], v[84:87], v[12:15]
    buffer_load_dwordx4 v[80:83], v3, s[48:51], s8 offen offset:0 nt
    buffer_load_dwordx4 v[84:87], v3, s[48:51], s8 offen offset:1024 nt
    v_and_b32_dpp v36, v41, v4 row_newbcast:12 row_mask:0xf bank_mask:0xf
    v_and_b32_dpp v37, v41, v5 row_newbcast:12 row_mask:0xf bank_mask:0xf
    v_and_b32_dpp v38, v41, v6 row_newbcast:12 row_mask:0xf bank_mask:0xf
    v_and_b32_dpp v39, v41, v7 row_newbcast:12 row_mask:0xf bank_mask:0xf
    s_waitcnt vmcnt(15)
    v_mfma_f32_16x16x32_bf16 v[12:15], v[32:35], v[88:91], v[12:15]
    buffer_load_dwordx4 v[88:91], v3, s[48:51], s8 offen offset:2048 nt
    s_waitcnt vmcnt(15)
    v_mfma_f32_16x16x32_bf16 v[12:15], v[36:39], v[92:95], v[12:15]
    buffer_load_dwordx4 v[92:95], v3, s[48:51], s8 offen offset:3072 nt
    v_lshlrev_b32 v40, 16, v61
    v_and_b32 v41, s68, v61
    ds_read_b32 v61, v62 offset:16640
    v_fma_f32 v46, v40, s10, -v44
    v_fma_f32 v47, v41, s10, -v44
    v_exp_f32 v46, v46
    v_exp_f32 v47, v47
    v_add_f32 v17, v17, v46
    v_cvt_pk_bf16_f32 v40, v46, v46
    v_cvt_pk_bf16_f32 v41, v47, v47
    v_add_f32 v17, v17, v47
    v_and_b32_dpp v32, v40, v4 row_newbcast:0 row_mask:0xf bank_mask:0xf
    v_and_b32_dpp v33, v40, v5 row_newbcast:0 row_mask:0xf bank_mask:0xf
    v_and_b32_dpp v34, v40, v6 row_newbcast:0 row_mask:0xf bank_mask:0xf
    v_and_b32_dpp v35, v40, v7 row_newbcast:0 row_mask:0xf bank_mask:0xf
    v_and_b32_dpp v36, v41, v4 row_newbcast:0 row_mask:0xf bank_mask:0xf
    v_and_b32_dpp v37, v41, v5 row_newbcast:0 row_mask:0xf bank_mask:0xf
    v_and_b32_dpp v38, v41, v6 row_newbcast:0 row_mask:0xf bank_mask:0xf
    v_and_b32_dpp v39, v41, v7 row_newbcast:0 row_mask:0xf bank_mask:0xf
    s_waitcnt vmcnt(15)
    v_mfma_f32_16x16x32_bf16 v[12:15], v[32:35], v[96:99], v[12:15]
    s_add_u32 s69, s89, 884736
    s_and_b32 s69, s69, 0xfffff
    buffer_load_dwordx4 v[96:99], v2, s[48:51], s69 offen offset:0 nt
    v_and_b32_dpp v32, v40, v4 row_newbcast:4 row_mask:0xf bank_mask:0xf
    v_and_b32_dpp v33, v40, v5 row_newbcast:4 row_mask:0xf bank_mask:0xf
    v_and_b32_dpp v34, v40, v6 row_newbcast:4 row_mask:0xf bank_mask:0xf
    v_and_b32_dpp v35, v40, v7 row_newbcast:4 row_mask:0xf bank_mask:0xf
    s_waitcnt vmcnt(15)
    v_mfma_f32_16x16x32_bf16 v[12:15], v[36:39], v[100:103], v[12:15]
    buffer_load_dwordx4 v[100:103], v2, s[48:51], s69 offen offset:1024 nt
    v_and_b32_dpp v36, v41, v4 row_newbcast:4 row_mask:0xf bank_mask:0xf
    v_and_b32_dpp v37, v41, v5 row_newbcast:4 row_mask:0xf bank_mask:0xf
    v_and_b32_dpp v38, v41, v6 row_newbcast:4 row_mask:0xf bank_mask:0xf
    v_and_b32_dpp v39, v41, v7 row_newbcast:4 row_mask:0xf bank_mask:0xf
    s_waitcnt vmcnt(15)
    v_mfma_f32_16x16x32_bf16 v[12:15], v[32:35], v[104:107], v[12:15]
    buffer_load_dwordx4 v[104:107], v2, s[48:51], s69 offen offset:2048 nt
    v_and_b32_dpp v32, v40, v4 row_newbcast:8 row_mask:0xf bank_mask:0xf
    v_and_b32_dpp v33, v40, v5 row_newbcast:8 row_mask:0xf bank_mask:0xf
    v_and_b32_dpp v34, v40, v6 row_newbcast:8 row_mask:0xf bank_mask:0xf
    v_and_b32_dpp v35, v40, v7 row_newbcast:8 row_mask:0xf bank_mask:0xf
    s_waitcnt vmcnt(15)
    v_mfma_f32_16x16x32_bf16 v[12:15], v[36:39], v[108:111], v[12:15]
    buffer_load_dwordx4 v[108:111], v2, s[48:51], s69 offen offset:3072 nt
    v_and_b32_dpp v36, v41, v4 row_newbcast:8 row_mask:0xf bank_mask:0xf
    v_and_b32_dpp v37, v41, v5 row_newbcast:8 row_mask:0xf bank_mask:0xf
    v_and_b32_dpp v38, v41, v6 row_newbcast:8 row_mask:0xf bank_mask:0xf
    v_and_b32_dpp v39, v41, v7 row_newbcast:8 row_mask:0xf bank_mask:0xf
    s_waitcnt vmcnt(15)
    v_mfma_f32_16x16x32_bf16 v[12:15], v[32:35], v[112:115], v[12:15]
    buffer_load_dwordx4 v[112:115], v3, s[48:51], s69 offen offset:0 nt
    v_and_b32_dpp v32, v40, v4 row_newbcast:12 row_mask:0xf bank_mask:0xf
    v_and_b32_dpp v33, v40, v5 row_newbcast:12 row_mask:0xf bank_mask:0xf
    v_and_b32_dpp v34, v40, v6 row_newbcast:12 row_mask:0xf bank_mask:0xf
    v_and_b32_dpp v35, v40, v7 row_newbcast:12 row_mask:0xf bank_mask:0xf
    s_waitcnt vmcnt(15)
    v_mfma_f32_16x16x32_bf16 v[12:15], v[36:39], v[116:119], v[12:15]
    buffer_load_dwordx4 v[116:119], v3, s[48:51], s69 offen offset:1024 nt
    v_and_b32_dpp v36, v41, v4 row_newbcast:12 row_mask:0xf bank_mask:0xf
    v_and_b32_dpp v37, v41, v5 row_newbcast:12 row_mask:0xf bank_mask:0xf
    v_and_b32_dpp v38, v41, v6 row_newbcast:12 row_mask:0xf bank_mask:0xf
    v_and_b32_dpp v39, v41, v7 row_newbcast:12 row_mask:0xf bank_mask:0xf
    s_waitcnt vmcnt(15)
    v_mfma_f32_16x16x32_bf16 v[12:15], v[32:35], v[120:123], v[12:15]
    buffer_load_dwordx4 v[120:123], v3, s[48:51], s69 offen offset:2048 nt
    s_waitcnt vmcnt(15)
    v_mfma_f32_16x16x32_bf16 v[12:15], v[36:39], v[124:127], v[12:15]
    buffer_load_dwordx4 v[124:127], v3, s[48:51], s69 offen offset:3072 nt
    v_add_u32 v62, 512, v62
    s_waitcnt lgkmcnt(0)
    s_add_u32 s8, s89, 917504
    s_and_b32 s8, s8, 0xfffff
    s_add_u32 s69, s89, 950272
    s_and_b32 s69, s69, 0xfffff
    s_mov_b32 s9, 1
L_vloop2:
    v_lshlrev_b32 v40, 16, v60
    v_and_b32 v41, s68, v60
    ds_read_b32 v60, v62 offset:16384
    v_fma_f32 v46, v40, s10, -v44
    v_fma_f32 v47, v41, s10, -v44
    v_exp_f32 v46, v46
    v_exp_f32 v47, v47
    v_add_f32 v17, v17, v46
    v_cvt_pk_bf16_f32 v40, v46, v46
    v_cvt_pk_bf16_f32 v41, v47, v47
    v_add_f32 v17, v17, v47
    v_and_b32_dpp v32, v40, v4 row_newbcast:0 row_mask:0xf bank_mask:0xf
    v_and_b32_dpp v33, v40, v5 row_newbcast:0 row_mask:0xf bank_mask:0xf
    v_and_b32_dpp v34, v40, v6 row_newbcast:0 row_mask:0xf bank_mask:0xf
    v_and_b32_dpp v35, v40, v7 row_newbcast:0 row_mask:0xf bank_mask:0xf
    v_and_b32_dpp v36, v41, v4 row_newbcast:0 row_mask:0xf bank_mask:0xf
    v_and_b32_dpp v37, v41, v5 row_newbcast:0 row_mask:0xf bank_mask:0xf
    v_and_b32_dpp v38, v41, v6 row_newbcast:0 row_mask:0xf bank_mask:0xf
    v_and_b32_dpp v39, v41, v7 row_newbcast:0 row_mask:0xf bank_mask:0xf
    s_waitcnt vmcnt(15)
    v_mfma_f32_16x16x32_bf16 v[12:15], v[32:35], v[64:67], v[12:15]
    buffer_load_dwordx4 v[64:67], v2, s[48:51], s8 offen offset:0 nt
    v_and_b32_dpp v32, v40, v4 row_newbcast:4 row_mask:0xf bank_mask:0xf
    v_and_b32_dpp v33, v40, v5 row_newbcast:4 row_mask:0xf bank_mask:0xf
    v_and_b32_dpp v34, v40, v6 row_newbcast:4 row_mask:0xf bank_mask:0xf
    v_and_b32_dpp v35, v40, v7 row_newbcast:4 row_mask:0xf bank_mask:0xf
    s_waitcnt vmcnt(15)
    v_mfma_f32_16x16x32_bf16 v[12:15], v[36:39], v[68:71], v[12:15]
    buffer_load_dwordx4 v[68:71], v2, s[48:51], s8 offen offset:1024 nt
    v_and_b32_dpp v36, v41, v4 row_newbcast:4 row_mask:0xf bank_mask:0xf
    v_and_b32_dpp v37, v41, v5 row_newbcast:4 row_mask:0xf bank_mask:0xf
    v_and_b32_dpp v38, v41, v6 row_newbcast:4 row_mask:0xf bank_mask:0xf
    v_and_b32_dpp v39, v41, v7 row_newbcast:4 row_mask:0xf bank_mask:0xf
    s_waitcnt vmcnt(15)
    v_mfma_f32_16x16x32_bf16 v[12:15], v[32:35], v[72:75], v[12:15]
    buffer_load_dwordx4 v[72:75], v2, s[48:51], s8 offen offset:2048 nt
    v_and_b32_dpp v32, v40, v4 row_newbcast:8 row_mask:0xf bank_mask:0xf
    v_and_b32_dpp v33, v40, v5 row_newbcast:8 row_mask:0xf bank_mask:0xf
    v_and_b32_dpp v34, v40, v6 row_newbcast:8 row_mask:0xf bank_mask:0xf
    v_and_b32_dpp v35, v40, v7 row_newbcast:8 row_mask:0xf bank_mask:0xf
    s_waitcnt vmcnt(15)
    v_mfma_f32_16x16x32_bf16 v[12:15], v[36:39], v[76:79], v[12:15]
    buffer_load_dwordx4 v[76:79], v2, s[48:51], s8 offen offset:3072 nt
    v_and_b32_dpp v36, v41, v4 row_newbcast:8 row_mask:0xf bank_mask:0xf
    v_and_b32_dpp v37, v41, v5 row_newbcast:8 row_mask:0xf bank_mask:0xf
    v_and_b32_dpp v38, v41, v6 row_newbcast:8 row_mask:0xf bank_mask:0xf
    v_and_b32_dpp v39, v41, v7 row_newbcast:8 row_mask:0xf bank_mask:0xf
    s_waitcnt vmcnt(15)
    v_mfma_f32_16x16x32_bf16 v[12:15], v[32:35], v[80:83], v[12:15]
    buffer_load_dwordx4 v[80:83], v3, s[48:51], s8 offen offset:0 nt
    v_and_b32_dpp v32, v40, v4 row_newbcast:12 row_mask:0xf bank_mask:0xf
    v_and_b32_dpp v33, v40, v5 row_newbcast:12 row_mask:0xf bank_mask:0xf
    v_and_b32_dpp v34, v40, v6 row_newbcast:12 row_mask:0xf bank_mask:0xf
    v_and_b32_dpp v35, v40, v7 row_newbcast:12 row_mask:0xf bank_mask:0xf
    s_waitcnt vmcnt(15)
    v_mfma_f32_16x16x32_bf16 v[12:15], v[36:39], v[84:87], v[12:15]
    buffer_load_dwordx4 v[84:87], v3, s[48:51], s8 offen offset:1024 nt
    v_and_b32_dpp v36, v41, v4 row_newbcast:12 row_mask:0xf bank_mask:0xf
    v_and_b32_dpp v37, v41, v5 row_newbcast:12 row_mask:0xf bank_mask:0xf
    v_and_b32_dpp v38, v41, v6 row_newbcast:12 row_mask:0xf bank_mask:0xf
    v_and_b32_dpp v39, v41, v7 row_newbcast:12 row_mask:0xf bank_mask:0xf
    s_waitcnt vmcnt(15)
    v_mfma_f32_16x16x32_bf16 v[12:15], v[32:35], v[88:91], v[12:15]
    buffer_load_dwordx4 v[88:91], v3, s[48:51], s8 offen offset:2048 nt
    s_waitcnt vmcnt(15)
    v_mfma_f32_16x16x32_bf16 v[12:15], v[36:39], v[92:95], v[12:15]
    buffer_load_dwordx4 v[92:95], v3, s[48:51], s8 offen offset:3072 nt
    s_mov_b32 s8, s69
    s_add_u32 s69, s69, 32768
    s_and_b32 s69, s69, 0xfffff
    v_lshlrev_b32 v40, 16, v61
    v_and_b32 v41, s68, v61
    ds_read_b32 v61, v62 offset:16640
    v_fma_f32 v46, v40, s10, -v44
    v_fma_f32 v47, v41, s10, -v44
    v_exp_f32 v46, v46
    v_exp_f32 v47, v47
    v_add_f32 v17, v17, v46
    v_cvt_pk_bf16_f32 v40, v46, v46
    v_cvt_pk_bf16_f32 v41, v47, v47
    v_add_f32 v17, v17, v47
    v_and_b32_dpp v32, v40, v4 row_newbcast:0 row_mask:0xf bank_mask:0xf
    v_and_b32_dpp v33, v40, v5 row_newbcast:0 row_mask:0xf bank_mask:0xf
    v_and_b32_dpp v34, v40, v6 row_newbcast:0 row_mask:0xf bank_mask:0xf
    v_and_b32_dpp v35, v40, v7 row_newbcast:0 row_mask:0xf bank_mask:0xf
    v_and_b32_dpp v36, v41, v4 row_newbcast:0 row_mask:0xf bank_mask:0xf
    v_and_b32_dpp v37, v41, v5 row_newbcast:0 row_mask:0xf bank_mask:0xf
    v_and_b32_dpp v38, v41, v6 row_newbcast:0 row_mask:0xf bank_mask:0xf
    v_and_b32_dpp v39, v41, v7 row_newbcast:0 row_mask:0xf bank_mask:0xf
    s_waitcnt vmcnt(15)
    v_mfma_f32_16x16x32_bf16 v[12:15], v[32:35], v[96:99], v[12:15]
    buffer_load_dwordx4 v[96:99], v2, s[48:51], s8 offen offset:0 nt
    v_and_b32_dpp v32, v40, v4 row_newbcast:4 row_mask:0xf bank_mask:0xf
    v_and_b32_dpp v33, v40, v5 row_newbcast:4 row_mask:0xf bank_mask:0xf
    v_and_b32_dpp v34, v40, v6 row_newbcast:4 row_mask:0xf bank_mask:0xf
    v_and_b32_dpp v35, v40, v7 row_newbcast:4 row_mask:0xf bank_mask:0xf
    s_waitcnt vmcnt(15)
    v_mfma_f32_16x16x32_bf16 v[12:15], v[36:39], v[100:103], v[12:15]
    buffer_load_dwordx4 v[100:103], v2, s[48:51], s8 offen offset:1024 nt
    v_and_b32_dpp v36, v41, v4 row_newbcast:4 row_mask:0xf bank_mask:0xf
    v_and_b32_dpp v37, v41, v5 row_newbcast:4 row_mask:0xf bank_mask:0xf
    v_and_b32_dpp v38, v41, v6 row_newbcast:4 row_mask:0xf bank_mask:0xf
    v_and_b32_dpp v39, v41, v7 row_newbcast:4 row_mask:0xf bank_mask:0xf
    s_waitcnt vmcnt(15)
    v_mfma_f32_16x16x32_bf16 v[12:15], v[32:35], v[104:107], v[12:15]
    buffer_load_dwordx4 v[104:107], v2, s[48:51], s8 offen offset:2048 nt
    v_and_b32_dpp v32, v40, v4 row_newbcast:8 row_mask:0xf bank_mask:0xf
    v_and_b32_dpp v33, v40, v5 row_newbcast:8 row_mask:0xf bank_mask:0xf
    v_and_b32_dpp v34, v40, v6 row_newbcast:8 row_mask:0xf bank_mask:0xf
    v_and_b32_dpp v35, v40, v7 row_newbcast:8 row_mask:0xf bank_mask:0xf
    s_waitcnt vmcnt(15)
    v_mfma_f32_16x16x32_bf16 v[12:15], v[36:39], v[108:111], v[12:15]
    buffer_load_dwordx4 v[108:111], v2, s[48:51], s8 offen offset:3072 nt
    v_and_b32_dpp v36, v41, v4 row_newbcast:8 row_mask:0xf bank_mask:0xf
    v_and_b32_dpp v37, v41, v5 row_newbcast:8 row_mask:0xf bank_mask:0xf
    v_and_b32_dpp v38, v41, v6 row_newbcast:8 row_mask:0xf bank_mask:0xf
    v_and_b32_dpp v39, v41, v7 row_newbcast:8 row_mask:0xf bank_mask:0xf
    s_waitcnt vmcnt(15)
    v_mfma_f32_16x16x32_bf16 v[12:15], v[32:35], v[112:115], v[12:15]
    buffer_load_dwordx4 v[112:115], v3, s[48:51], s8 offen offset:0 nt
    v_and_b32_dpp v32, v40, v4 row_newbcast:12 row_mask:0xf bank_mask:0xf
    v_and_b32_dpp v33, v40, v5 row_newbcast:12 row_mask:0xf bank_mask:0xf
    v_and_b32_dpp v34, v40, v6 row_newbcast:12 row_mask:0xf bank_mask:0xf
    v_and_b32_dpp v35, v40, v7 row_newbcast:12 row_mask:0xf bank_mask:0xf
    s_waitcnt vmcnt(15)
    v_mfma_f32_16x16x32_bf16 v[12:15], v[36:39], v[116:119], v[12:15]
    buffer_load_dwordx4 v[116:119], v3, s[48:51], s8 offen offset:1024 nt
    v_and_b32_dpp v36, v41, v4 row_newbcast:12 row_mask:0xf bank_mask:0xf
    v_and_b32_dpp v37, v41, v5 row_newbcast:12 row_mask:0xf bank_mask:0xf
    v_and_b32_dpp v38, v41, v6 row_newbcast:12 row_mask:0xf bank_mask:0xf
    v_and_b32_dpp v39, v41, v7 row_newbcast:12 row_mask:0xf bank_mask:0xf
    s_waitcnt vmcnt(15)
    v_mfma_f32_16x16x32_bf16 v[12:15], v[32:35], v[120:123], v[12:15]
    buffer_load_dwordx4 v[120:123], v3, s[48:51], s8 offen offset:2048 nt
    s_waitcnt vmcnt(15)
    v_mfma_f32_16x16x32_bf16 v[12:15], v[36:39], v[124:127], v[12:15]
    buffer_load_dwordx4 v[124:127], v3, s[48:51], s8 offen offset:3072 nt
    s_mov_b32 s8, s69
    s_add_u32 s69, s69, 32768
    s_and_b32 s69, s69, 0xfffff
    v_add_u32 v62, 512, v62
    s_sub_u32 s9, s9, 1
    s_cmp_lg_u32 s9, 0
    s_waitcnt lgkmcnt(0)
    s_cbranch_scc1 L_vloop2
    v_lshlrev_b32 v40, 16, v60
    v_and_b32 v41, s68, v60
    ds_read_b32 v60, v62 offset:16384
    v_fma_f32 v46, v40, s10, -v44
    v_fma_f32 v47, v41, s10, -v44
    v_exp_f32 v46, v46
    v_exp_f32 v47, v47
    v_add_f32 v17, v17, v46
    v_cvt_pk_bf16_f32 v40, v46, v46
    v_cvt_pk_bf16_f32 v41, v47, v47
    v_add_f32 v17, v17, v47
    v_and_b32_dpp v32, v40, v4 row_newbcast:0 row_mask:0xf bank_mask:0xf
    v_and_b32_dpp v33, v40, v5 row_newbcast:0 row_mask:0xf bank_mask:0xf
    v_and_b32_dpp v34, v40, v6 row_newbcast:0 row_mask:0xf bank_mask:0xf
    v_and_b32_dpp v35, v40, v7 row_newbcast:0 row_mask:0xf bank_mask:0xf
    v_and_b32_dpp v36, v41, v4 row_newbcast:0 row_mask:0xf bank_mask:0xf
    v_and_b32_dpp v37, v41, v5 row_newbcast:0 row_mask:0xf bank_mask:0xf
    v_and_b32_dpp v38, v41, v6 row_newbcast:0 row_mask:0xf bank_mask:0xf
    v_and_b32_dpp v39, v41, v7 row_newbcast:0 row_mask:0xf bank_mask:0xf
    s_waitcnt vmcnt(15)
    v_mfma_f32_16x16x32_bf16 v[12:15], v[32:35], v[64:67], v[12:15]
    s_add_u32 s8, s89, 983040
    s_and_b32 s8, s8, 0xfffff
    buffer_load_dwordx4 v[64:67], v2, s[48:51], s8 offen offset:0 nt
    v_and_b32_dpp v32, v40, v4 row_newbcast:4 row_mask:0xf bank_mask:0xf
    v_and_b32_dpp v33, v40, v5 row_newbcast:4 row_mask:0xf bank_mask:0xf
    v_and_b32_dpp v34, v40, v6 row_newbcast:4 row_mask:0xf bank_mask:0xf
    v_and_b32_dpp v35, v40, v7 row_newbcast:4 row_mask:0xf bank_mask:0xf
    s_waitcnt vmcnt(15)
    v_mfma_f32_16x16x32_bf16 v[12:15], v[36:39], v[68:71], v[12:15]
    buffer_load_dwordx4 v[68:71], v2, s[48:51], s8 offen offset:1024 nt
    v_and_b32_dpp v36, v41, v4 row_newbcast:4 row_mask:0xf bank_mask:0xf
    v_and_b32_dpp v37, v41, v5 row_newbcast:4 row_mask:0xf bank_mask:0xf
    v_and_b32_dpp v38, v41, v6 row_newbcast:4 row_mask:0xf bank_mask:0xf
    v_and_b32_dpp v39, v41, v7 row_newbcast:4 row_mask:0xf bank_mask:0xf
    s_waitcnt vmcnt(15)
    v_mfma_f32_16x16x32_bf16 v[12:15], v[32:35], v[72:75], v[12:15]
    buffer_load_dwordx4 v[72:75], v2, s[48:51], s8 offen offset:2048 nt
    v_and_b32_dpp v32, v40, v4 row_newbcast:8 row_mask:0xf bank_mask:0xf
    v_and_b32_dpp v33, v40, v5 row_newbcast:8 row_mask:0xf bank_mask:0xf
    v_and_b32_dpp v34, v40, v6 row_newbcast:8 row_mask:0xf bank_mask:0xf
    v_and_b32_dpp v35, v40, v7 row_newbcast:8 row_mask:0xf bank_mask:0xf
    s_waitcnt vmcnt(15)
    v_mfma_f32_16x16x32_bf16 v[12:15], v[36:39], v[76:79], v[12:15]
    buffer_load_dwordx4 v[76:79], v2, s[48:51], s8 offen offset:3072 nt
    v_and_b32_dpp v36, v41, v4 row_newbcast:8 row_mask:0xf bank_mask:0xf
    v_and_b32_dpp v37, v41, v5 row_newbcast:8 row_mask:0xf bank_mask:0xf
    v_and_b32_dpp v38, v41, v6 row_newbcast:8 row_mask:0xf bank_mask:0xf
    v_and_b32_dpp v39, v41, v7 row_newbcast:8 row_mask:0xf bank_mask:0xf
    s_waitcnt vmcnt(15)
    v_mfma_f32_16x16x32_bf16 v[12:15], v[32:35], v[80:83], v[12:15]
    buffer_load_dwordx4 v[80:83], v3, s[48:51], s8 offen offset:0 nt
    v_and_b32_dpp v32, v40, v4 row_newbcast:12 row_mask:0xf bank_mask:0xf
    v_and_b32_dpp v33, v40, v5 row_newbcast:12 row_mask:0xf bank_mask:0xf
    v_and_b32_dpp v34, v40, v6 row_newbcast:12 row_mask:0xf bank_mask:0xf
    v_and_b32_dpp v35, v40, v7 row_newbcast:12 row_mask:0xf bank_mask:0xf
    s_waitcnt vmcnt(15)
    v_mfma_f32_16x16x32_bf16 v[12:15], v[36:39], v[84:87], v[12:15]
    buffer_load_dwordx4 v[84:87], v3, s[48:51], s8 offen offset:1024 nt
    v_and_b32_dpp v36, v41, v4 row_newbcast:12 row_mask:0xf bank_mask:0xf
    v_and_b32_dpp v37, v41, v5 row_newbcast:12 row_mask:0xf bank_mask:0xf
    v_and_b32_dpp v38, v41, v6 row_newbcast:12 row_mask:0xf bank_mask:0xf
    v_and_b32_dpp v39, v41, v7 row_newbcast:12 row_mask:0xf bank_mask:0xf
    s_waitcnt vmcnt(15)
    v_mfma_f32_16x16x32_bf16 v[12:15], v[32:35], v[88:91], v[12:15]
    buffer_load_dwordx4 v[88:91], v3, s[48:51], s8 offen offset:2048 nt
    s_waitcnt vmcnt(15)
    v_mfma_f32_16x16x32_bf16 v[12:15], v[36:39], v[92:95], v[12:15]
    buffer_load_dwordx4 v[92:95], v3, s[48:51], s8 offen offset:3072 nt
    v_lshlrev_b32 v40, 16, v61
    v_and_b32 v41, s68, v61
    ds_read_b32 v61, v62 offset:16640
    v_fma_f32 v46, v40, s10, -v44
    v_fma_f32 v47, v41, s10, -v44
    v_exp_f32 v46, v46
    v_exp_f32 v47, v47
    v_add_f32 v17, v17, v46
    v_cvt_pk_bf16_f32 v40, v46, v46
    v_cvt_pk_bf16_f32 v41, v47, v47
    v_add_f32 v17, v17, v47
    v_and_b32_dpp v32, v40, v4 row_newbcast:0 row_mask:0xf bank_mask:0xf
    v_and_b32_dpp v33, v40, v5 row_newbcast:0 row_mask:0xf bank_mask:0xf
    v_and_b32_dpp v34, v40, v6 row_newbcast:0 row_mask:0xf bank_mask:0xf
    v_and_b32_dpp v35, v40, v7 row_newbcast:0 row_mask:0xf bank_mask:0xf
    v_and_b32_dpp v36, v41, v4 row_newbcast:0 row_mask:0xf bank_mask:0xf
    v_and_b32_dpp v37, v41, v5 row_newbcast:0 row_mask:0xf bank_mask:0xf
    v_and_b32_dpp v38, v41, v6 row_newbcast:0 row_mask:0xf bank_mask:0xf
    v_and_b32_dpp v39, v41, v7 row_newbcast:0 row_mask:0xf bank_mask:0xf
    s_waitcnt vmcnt(15)
    v_mfma_f32_16x16x32_bf16 v[12:15], v[32:35], v[96:99], v[12:15]
    s_add_u32 s69, s89, 1015808
    s_and_b32 s69, s69, 0xfffff
    buffer_load_dwordx4 v[96:99], v2, s[48:51], s69 offen offset:0 nt
    v_and_b32_dpp v32, v40, v4 row_newbcast:4 row_mask:0xf bank_mask:0xf
    v_and_b32_dpp v33, v40, v5 row_newbcast:4 row_mask:0xf bank_mask:0xf
    v_and_b32_dpp v34, v40, v6 row_newbcast:4 row_mask:0xf bank_mask:0xf
    v_and_b32_dpp v35, v40, v7 row_newbcast:4 row_mask:0xf bank_mask:0xf
    s_waitcnt vmcnt(15)
    v_mfma_f32_16x16x32_bf16 v[12:15], v[36:39], v[100:103], v[12:15]
    buffer_load_dwordx4 v[100:103], v2, s[48:51], s69 offen offset:1024 nt
    v_and_b32_dpp v36, v41, v4 row_newbcast:4 row_mask:0xf bank_mask:0xf
    v_and_b32_dpp v37, v41, v5 row_newbcast:4 row_mask:0xf bank_mask:0xf
    v_and_b32_dpp v38, v41, v6 row_newbcast:4 row_mask:0xf bank_mask:0xf
    v_and_b32_dpp v39, v41, v7 row_newbcast:4 row_mask:0xf bank_mask:0xf
    s_waitcnt vmcnt(15)
    v_mfma_f32_16x16x32_bf16 v[12:15], v[32:35], v[104:107], v[12:15]
    buffer_load_dwordx4 v[104:107], v2, s[48:51], s69 offen offset:2048 nt
    v_and_b32_dpp v32, v40, v4 row_newbcast:8 row_mask:0xf bank_mask:0xf
    v_and_b32_dpp v33, v40, v5 row_newbcast:8 row_mask:0xf bank_mask:0xf
    v_and_b32_dpp v34, v40, v6 row_newbcast:8 row_mask:0xf bank_mask:0xf
    v_and_b32_dpp v35, v40, v7 row_newbcast:8 row_mask:0xf bank_mask:0xf
    s_waitcnt vmcnt(15)
    v_mfma_f32_16x16x32_bf16 v[12:15], v[36:39], v[108:111], v[12:15]
    buffer_load_dwordx4 v[108:111], v2, s[48:51], s69 offen offset:3072 nt
    v_and_b32_dpp v36, v41, v4 row_newbcast:8 row_mask:0xf bank_mask:0xf
    v_and_b32_dpp v37, v41, v5 row_newbcast:8 row_mask:0xf bank_mask:0xf
    v_and_b32_dpp v38, v41, v6 row_newbcast:8 row_mask:0xf bank_mask:0xf
    v_and_b32_dpp v39, v41, v7 row_newbcast:8 row_mask:0xf bank_mask:0xf
    s_waitcnt vmcnt(15)
    v_mfma_f32_16x16x32_bf16 v[12:15], v[32:35], v[112:115], v[12:15]
    buffer_load_dwordx4 v[112:115], v3, s[48:51], s69 offen offset:0 nt
    v_and_b32_dpp v32, v40, v4 row_newbcast:12 row_mask:0xf bank_mask:0xf
    v_and_b32_dpp v33, v40, v5 row_newbcast:12 row_mask:0xf bank_mask:0xf
    v_and_b32_dpp v34, v40, v6 row_newbcast:12 row_mask:0xf bank_mask:0xf
    v_and_b32_dpp v35, v40, v7 row_newbcast:12 row_mask:0xf bank_mask:0xf
    s_waitcnt vmcnt(15)
    v_mfma_f32_16x16x32_bf16 v[12:15], v[36:39], v[116:119], v[12:15]
    buffer_load_dwordx4 v[116:119], v3, s[48:51], s69 offen offset:1024 nt
    v_and_b32_dpp v36, v41, v4 row_newbcast:12 row_mask:0xf bank_mask:0xf
    v_and_b32_dpp v37, v41, v5 row_newbcast:12 row_mask:0xf bank_mask:0xf
    v_and_b32_dpp v38, v41, v6 row_newbcast:12 row_mask:0xf bank_mask:0xf
    v_and_b32_dpp v39, v41, v7 row_newbcast:12 row_mask:0xf bank_mask:0xf
    s_waitcnt vmcnt(15)
    v_mfma_f32_16x16x32_bf16 v[12:15], v[32:35], v[120:123], v[12:15]
    buffer_load_dwordx4 v[120:123], v3, s[48:51], s69 offen offset:2048 nt
    s_waitcnt vmcnt(15)
    v_mfma_f32_16x16x32_bf16 v[12:15], v[36:39], v[124:127], v[12:15]
    buffer_load_dwordx4 v[124:127], v3, s[48:51], s69 offen offset:3072 nt
    s_lshl_b32 s14, s6, 3
    s_add_u32 s14, s14, 590848
    s_cmp_eq_u32 s3, 0
    s_cselect_b32 s14, s14, 2097152
    v_mov_b32 v52, s90
    v_mov_b32 v53, s91
    v_mov_b32 v54, s14
    s_mov_b64 exec, 1
    buffer_store_dwordx2 v[52:53], v54, s[60:63], 0 offen sc1
    s_mov_b64 exec, -1
    v_add_u32 v62, 512, v62
    s_waitcnt lgkmcnt(0)
    v_lshlrev_b32 v40, 16, v60
    v_and_b32 v41, s68, v60
    v_fma_f32 v46, v40, s10, -v44
    v_fma_f32 v47, v41, s10, -v44
    v_exp_f32 v46, v46
    v_exp_f32 v47, v47
    v_add_f32 v17, v17, v46
    v_cvt_pk_bf16_f32 v40, v46, v46
    v_cvt_pk_bf16_f32 v41, v47, v47
    v_add_f32 v17, v17, v47
    v_and_b32_dpp v32, v40, v4 row_newbcast:0 row_mask:0xf bank_mask:0xf
    v_and_b32_dpp v33, v40, v5 row_newbcast:0 row_mask:0xf bank_mask:0xf
    v_and_b32_dpp v34, v40, v6 row_newbcast:0 row_mask:0xf bank_mask:0xf
    v_and_b32_dpp v35, v40, v7 row_newbcast:0 row_mask:0xf bank_mask:0xf
    v_and_b32_dpp v36, v41, v4 row_newbcast:0 row_mask:0xf bank_mask:0xf
    v_and_b32_dpp v37, v41, v5 row_newbcast:0 row_mask:0xf bank_mask:0xf
    v_and_b32_dpp v38, v41, v6 row_newbcast:0 row_mask:0xf bank_mask:0xf
    v_and_b32_dpp v39, v41, v7 row_newbcast:0 row_mask:0xf bank_mask:0xf
    s_waitcnt vmcnt(16)
    v_mfma_f32_16x16x32_bf16 v[12:15], v[32:35], v[64:67], v[12:15]
    v_and_b32_dpp v32, v40, v4 row_newbcast:4 row_mask:0xf bank_mask:0xf
    v_and_b32_dpp v33, v40, v5 row_newbcast:4 row_mask:0xf bank_mask:0xf
    v_and_b32_dpp v34, v40, v6 row_newbcast:4 row_mask:0xf bank_mask:0xf
    v_and_b32_dpp v35, v40, v7 row_newbcast:4 row_mask:0xf bank_mask:0xf
    s_waitcnt vmcnt(15)
    v_mfma_f32_16x16x32_bf16 v[12:15], v[36:39], v[68:71], v[12:15]
    v_and_b32_dpp v36, v41, v4 row_newbcast:4 row_mask:0xf bank_mask:0xf
    v_and_b32_dpp v37, v41, v5 row_newbcast:4 row_mask:0xf bank_mask:0xf
    v_and_b32_dpp v38, v41, v6 row_newbcast:4 row_mask:0xf bank_mask:0xf
    v_and_b32_dpp v39, v41, v7 row_newbcast:4 row_mask:0xf bank_mask:0xf
    s_waitcnt vmcnt(14)
    v_mfma_f32_16x16x32_bf16 v[12:15], v[32:35], v[72:75], v[12:15]
    v_and_b32_dpp v32, v40, v4 row_newbcast:8 row_mask:0xf bank_mask:0xf
    v_and_b32_dpp v33, v40, v5 row_newbcast:8 row_mask:0xf bank_mask:0xf
    v_and_b32_dpp v34, v40, v6 row_newbcast:8 row_mask:0xf bank_mask:0xf
    v_and_b32_dpp v35, v40, v7 row_newbcast:8 row_mask:0xf bank_mask:0xf
    s_waitcnt vmcnt(13)
    v_mfma_f32_16x16x32_bf16 v[12:15], v[36:39], v[76:79], v[12:15]
    v_and_b32_dpp v36, v41, v4 row_newbcast:8 row_mask:0xf bank_mask:0xf
    v_and_b32_dpp v37, v41, v5 row_newbcast:8 row_mask:0xf bank_mask:0xf
    v_and_b32_dpp v38, v41, v6 row_newbcast:8 row_mask:0xf bank_mask:0xf
    v_and_b32_dpp v39, v41, v7 row_newbcast:8 row_mask:0xf bank_mask:0xf
    s_waitcnt vmcnt(12)
    v_mfma_f32_16x16x32_bf16 v[12:15], v[32:35], v[80:83], v[12:15]
    v_and_b32_dpp v32, v40, v4 row_newbcast:12 row_mask:0xf bank_mask:0xf
    v_and_b32_dpp v33, v40, v5 row_newbcast:12 row_mask:0xf bank_mask:0xf
    v_and_b32_dpp v34, v40, v6 row_newbcast:12 row_mask:0xf bank_mask:0xf
    v_and_b32_dpp v35, v40, v7 row_newbcast:12 row_mask:0xf bank_mask:0xf
    s_waitcnt vmcnt(11)
    v_mfma_f32_16x16x32_bf16 v[12:15], v[36:39], v[84:87], v[12:15]
    v_and_b32_dpp v36, v41, v4 row_newbcast:12 row_mask:0xf bank_mask:0xf
    v_and_b32_dpp v37, v41, v5 row_newbcast:12 row_mask:0xf bank_mask:0xf
    v_and_b32_dpp v38, v41, v6 row_newbcast:12 row_mask:0xf bank_mask:0xf
    v_and_b32_dpp v39, v41, v7 row_newbcast:12 row_mask:0xf bank_mask:0xf
    s_waitcnt vmcnt(10)
    v_mfma_f32_16x16x32_bf16 v[12:15], v[32:35], v[88:91], v[12:15]
    s_waitcnt vmcnt(9)
    v_mfma_f32_16x16x32_bf16 v[12:15], v[36:39], v[92:95], v[12:15]
    v_lshlrev_b32 v40, 16, v61
    v_and_b32 v41, s68, v61
    v_fma_f32 v46, v40, s10, -v44
    v_fma_f32 v47, v41, s10, -v44
    v_exp_f32 v46, v46
    v_exp_f32 v47, v47
    v_add_f32 v17, v17, v46
    v_cvt_pk_bf16_f32 v40, v46, v46
    v_cvt_pk_bf16_f32 v41, v47, v47
    v_add_f32 v17, v17, v47
    v_and_b32_dpp v32, v40, v4 row_newbcast:0 row_mask:0xf bank_mask:0xf
    v_and_b32_dpp v33, v40, v5 row_newbcast:0 row_mask:0xf bank_mask:0xf
    v_and_b32_dpp v34, v40, v6 row_newbcast:0 row_mask:0xf bank_mask:0xf
    v_and_b32_dpp v35, v40, v7 row_newbcast:0 row_mask:0xf bank_mask:0xf
    v_and_b32_dpp v36, v41, v4 row_newbcast:0 row_mask:0xf bank_mask:0xf
    v_and_b32_dpp v37, v41, v5 row_newbcast:0 row_mask:0xf bank_mask:0xf
    v_and_b32_dpp v38, v41, v6 row_newbcast:0 row_mask:0xf bank_mask:0xf
    v_and_b32_dpp v39, v41, v7 row_newbcast:0 row_mask:0xf bank_mask:0xf
    s_waitcnt vmcnt(8)
    v_mfma_f32_16x16x32_bf16 v[12:15], v[32:35], v[96:99], v[12:15]
    v_and_b32_dpp v32, v40, v4 row_newbcast:4 row_mask:0xf bank_mask:0xf
    v_and_b32_dpp v33, v40, v5 row_newbcast:4 row_mask:0xf bank_mask:0xf
    v_and_b32_dpp v34, v40, v6 row_newbcast:4 row_mask:0xf bank_mask:0xf
    v_and_b32_dpp v35, v40, v7 row_newbcast:4 row_mask:0xf bank_mask:0xf
    s_waitcnt vmcnt(7)
    v_mfma_f32_16x16x32_bf16 v[12:15], v[36:39], v[100:103], v[12:15]
    v_and_b32_dpp v36, v41, v4 row_newbcast:4 row_mask:0xf bank_mask:0xf
    v_and_b32_dpp v37, v41, v5 row_newbcast:4 row_mask:0xf bank_mask:0xf
    v_and_b32_dpp v38, v41, v6 row_newbcast:4 row_mask:0xf bank_mask:0xf
    v_and_b32_dpp v39, v41, v7 row_newbcast:4 row_mask:0xf bank_mask:0xf
    s_waitcnt vmcnt(6)
    v_mfma_f32_16x16x32_bf16 v[12:15], v[32:35], v[104:107], v[12:15]
    v_and_b32_dpp v32, v40, v4 row_newbcast:8 row_mask:0xf bank_mask:0xf
    v_and_b32_dpp v33, v40, v5 row_newbcast:8 row_mask:0xf bank_mask:0xf
    v_and_b32_dpp v34, v40, v6 row_newbcast:8 row_mask:0xf bank_mask:0xf
    v_and_b32_dpp v35, v40, v7 row_newbcast:8 row_mask:0xf bank_mask:0xf
    s_waitcnt vmcnt(5)
    v_mfma_f32_16x16x32_bf16 v[12:15], v[36:39], v[108:111], v[12:15]
    v_and_b32_dpp v36, v41, v4 row_newbcast:8 row_mask:0xf bank_mask:0xf
    v_and_b32_dpp v37, v41, v5 row_newbcast:8 row_mask:0xf bank_mask:0xf
    v_and_b32_dpp v38, v41, v6 row_newbcast:8 row_mask:0xf bank_mask:0xf
    v_and_b32_dpp v39, v41, v7 row_newbcast:8 row_mask:0xf bank_mask:0xf
    s_waitcnt vmcnt(4)
    v_mfma_f32_16x16x32_bf16 v[12:15], v[32:35], v[112:115], v[12:15]
    v_and_b32_dpp v32, v40, v4 row_newbcast:12 row_mask:0xf bank_mask:0xf
    v_and_b32_dpp v33, v40, v5 row_newbcast:12 row_mask:0xf bank_mask:0xf
    v_and_b32_dpp v34, v40, v6 row_newbcast:12 row_mask:0xf bank_mask:0xf
    v_and_b32_dpp v35, v40, v7 row_newbcast:12 row_mask:0xf bank_mask:0xf
    s_waitcnt vmcnt(3)
    v_mfma_f32_16x16x32_bf16 v[12:15], v[36:39], v[116:119], v[12:15]
    v_and_b32_dpp v36, v41, v4 row_newbcast:12 row_mask:0xf bank_mask:0xf
    v_and_b32_dpp v37, v41, v5 row_newbcast:12 row_mask:0xf bank_mask:0xf
    v_and_b32_dpp v38, v41, v6 row_newbcast:12 row_mask:0xf bank_mask:0xf
    v_and_b32_dpp v39, v41, v7 row_newbcast:12 row_mask:0xf bank_mask:0xf
    s_waitcnt vmcnt(2)
    v_mfma_f32_16x16x32_bf16 v[12:15], v[32:35], v[120:123], v[12:15]
    s_waitcnt vmcnt(1)
    v_mfma_f32_16x16x32_bf16 v[12:15], v[36:39], v[124:127], v[12:15]
    v_add_f32_dpp v17, v17, v17 row_half_mirror row_mask:0xf bank_mask:0xf
    s_nop 1
    v_add_f32_dpp v17, v17, v17 row_mirror row_mask:0xf bank_mask:0xf
    s_nop 1
    v_add_f32_dpp v17, v17, v17 row_bcast:15 row_mask:0xa bank_mask:0xf
    s_nop 1
    v_add_f32_dpp v17, v17, v17 row_bcast:31 row_mask:0xc bank_mask:0xf
    s_nop 0
    v_readlane_b32 s14, v17, 63
    v_and_b32 v43, 15, v1
    v_lshrrev_b32 v44, 4, v1
    v_mov_b32 v17, s14
    v_lshlrev_b32 v40, 5, v43
    v_lshl_add_u32 v41, v44, 4, v40
    s_lshl_b32 s15, s3, 9
    s_lshl_b32 s14, s3, 3
    v_add_u32 v42, s15, v41
    v_mov_b32 v45, s14
    s_mov_b64 exec, 0xffffffff
    ds_write_b128 v42, v[12:15] offset:2048
    s_mov_b64 exec, -1
    ds_write_b64 v45, v[16:17] offset:4096
    v_lshlrev_b32 v46, 2, v1
    v_mov_b32 v45, 0
    s_waitcnt lgkmcnt(0)
    s_barrier
    ds_read_b128 v[18:21], v45 offset:4096
    ds_read_b128 v[22:25], v45 offset:4112
    ds_read_b32 v64, v46 offset:2048
    ds_read_b32 v65, v46 offset:2304
    ds_read_b32 v66, v46 offset:2560
    ds_read_b32 v67, v46 offset:2816
    ds_read_b32 v68, v46 offset:3072
    ds_read_b32 v69, v46 offset:3328
    ds_read_b32 v70, v46 offset:3584
    ds_read_b32 v71, v46 offset:3840
    s_waitcnt lgkmcnt(8)
    v_max_f32 v16, v18, v20
    v_max3_f32 v16, v16, v22, v24
    v_mul_f32 v47, s10, v16
    v_fma_f32 v18, v18, s10, -v47
    v_fma_f32 v20, v20, s10, -v47
    v_fma_f32 v22, v22, s10, -v47
    v_fma_f32 v24, v24, s10, -v47
    v_exp_f32 v18, v18
    v_exp_f32 v20, v20
    v_exp_f32 v22, v22
    v_exp_f32 v24, v24
    v_mul_f32 v17, v18, v19
    v_fma_f32 v17, v20, v21, v17
    v_fma_f32 v17, v22, v23, v17
    v_fma_f32 v17, v24, v25, v17
    s_waitcnt lgkmcnt(0)
    v_mul_f32 v50, v18, v64
    v_mul_f32 v51, v18, v65
    v_fma_f32 v50, v20, v66, v50
    v_fma_f32 v51, v20, v67, v51
    v_fma_f32 v50, v22, v68, v50
    v_fma_f32 v51, v22, v69, v51
    v_fma_f32 v50, v24, v70, v50
    v_fma_f32 v51, v24, v71, v51
    v_cvt_pk_bf16_f32 v50, v50, v50
    v_cvt_pk_bf16_f32 v51, v51, v51
    v_mov_b32 v12, 0
    v_mov_b32 v13, 0
    v_mov_b32 v14, 0
    v_mov_b32 v15, 0
    s_nop 1
    s_call_b64 s[12:13], L_proj
    s_lshl_b32 s14, s6, 11
    s_lshl_b32 s15, s3, 9
    s_add_u32 s14, s14, s15
    v_add_u32 v41, s14, v41
    s_mov_b64 exec, 0xffffffff
    buffer_store_dwordx4 v[12:15], v41, s[60:63], 0 offen sc1
    s_mov_b64 exec, 1
    s_lshl_b32 s14, s6, 3
    s_add_u32 s14, s14, 524288
    v_mov_b32 v42, s14
    s_cmp_lg_u32 s3, 0
    s_cbranch_scc1 L_noml
    buffer_store_dwordx2 v[16:17], v42, s[60:63], 0 offen sc1
L_noml:
    s_mov_b64 exec, -1
    s_cmp_eq_u32 s6, 1
    s_cbranch_scc1 L_keeper
    s_cmp_lg_u32 s88, 0
    s_cbranch_scc1 L_fin
    s_lshr_b32 s4, s4, 1
    v_and_b32 v64, 31, v0
    v_lshrrev_b32 v65, 5, v0
    s_lshl_b32 s14, s5, 6
    v_lshl_add_u32 v67, v65, 3, s14
    v_lshlrev_b32 v66, 11, v67
    s_lshl_b32 s15, s4, 7
    v_lshl_add_u32 v68, v64, 2, s15
    v_add_u32 v66, v66, v68
    v_lshlrev_b32 v67, 3, v67
    v_add_u32 v67, 524288, v67
    s_lshl_b32 s14, s5, 11
    v_mul_u32_u24 v102, 57344, v65
    v_add3_u32 v68, v68, v102, s14
    s_mov_b32 s43, 0
    v_lshlrev_b32 v104, 16, v57
    v_and_b32 v105, s68, v57
    v_lshlrev_b32 v106, 16, v58
    v_and_b32 v107, s68, v58
    v_mul_f32 v104, v104, v106
    v_mul_f32 v105, v105, v107
    v_cvt_pk_bf16_f32 v104, v104, v105
    v_lshlrev_b32 v105, 16, v104
    v_and_b32 v104, s68, v104
    v_add_f32 v104, v104, v105
    s_nop 1
    v_add_f32_dpp v104, v104, v104 quad_perm:[1,0,3,2] row_mask:0xf bank_mask:0xf
    s_nop 1
    v_add_f32_dpp v104, v104, v104 quad_perm:[2,3,0,1] row_mask:0xf bank_mask:0xf
    s_nop 1
    v_add_f32_dpp v104, v104, v104 row_half_mirror row_mask:0xf bank_mask:0xf
    s_nop 1
    v_add_f32_dpp v104, v104, v104 row_mirror row_mask:0xf bank_mask:0xf
    s_nop 1
    v_add_f32_dpp v104, v104, v104 row_bcast:15 row_mask:0xa bank_mask:0xf
    s_nop 1
    v_add_f32_dpp v104, v104, v104 row_bcast:31 row_mask:0xc bank_mask:0xf
    s_nop 0
    v_readlane_b32 s15, v104, 63
    s_lshl_b32 s7, s3, 2
    v_mov_b32 v105, s7
    v_mov_b32 v104, s15
    ds_write_b32 v105, v104 offset:8192
    s_add_u32 s48, s40, 1048576
    s_addc_u32 s49, s41, 0
    s_and_b32 s49, s49, 0xffff
    s_mov_b32 s50, 458752
    s_mov_b32 s51, 0x20000
    s_cmp_lg_u32 s3, 0
    s_cbranch_scc1 L_pollok
    s_lshl_b32 s14, s5, 9
    s_add_u32 s14, s14, 590848
    v_lshl_add_u32 v103, v1, 3, s14
    s_lshr_b32 s14, s4, 2
    s_lshl_b32 s14, s14, 9
    s_add_u32 s14, s14, 598016
    v_min_u32 v108, 55, v1
    v_lshl_add_u32 v108, v108, 3, s14
L_apoll:
    buffer_load_dwordx2 v[110:111], v103, s[60:63], 0 offen sc1
    buffer_load_dwordx2 v[120:121], v108, s[60:63], 0 offen sc1
    s_waitcnt vmcnt(0)
    v_cmp_ne_u64 vcc, s[90:91], v[110:111]
    s_mov_b64 s[14:15], vcc
    v_cmp_ne_u64 vcc, s[90:91], v[120:121]
    s_or_b64 s[14:15], s[14:15], vcc
    s_cmp_eq_u64 s[14:15], 0
    s_cbranch_scc1 L_pollok
    s_add_u32 s43, s43, 1
    s_cmp_ge_u32 s43, 262144
    s_cbranch_scc1 L_fin
    s_sleep 32
    s_branch L_apoll
L_pollok:
    s_waitcnt lgkmcnt(0)
    s_barrier
    s_mov_b32 s7, 0
    buffer_load_dword v112, v68, s[48:51], s7 offen sc1
    s_mov_b32 s7, 8192
    buffer_load_dword v113, v68, s[48:51], s7 offen sc1
    s_mov_b32 s7, 16384
    buffer_load_dword v114, v68, s[48:51], s7 offen sc1
    s_mov_b32 s7, 24576
    buffer_load_dword v115, v68, s[48:51], s7 offen sc1
    s_mov_b32 s7, 32768
    buffer_load_dword v116, v68, s[48:51], s7 offen sc1
    s_mov_b32 s7, 40960
    buffer_load_dword v117, v68, s[48:51], s7 offen sc1
    s_mov_b32 s7, 49152
    buffer_load_dword v118, v68, s[48:51], s7 offen sc1
    s_mov_b32 s7, 0
    buffer_load_dword v72, v66, s[60:63], s7 offen sc1
    s_mov_b32 s7, 2048
    buffer_load_dword v73, v66, s[60:63], s7 offen sc1
    s_mov_b32 s7, 4096
    buffer_load_dword v74, v66, s[60:63], s7 offen sc1
    s_mov_b32 s7, 6144
    buffer_load_dword v75, v66, s[60:63], s7 offen sc1
    s_mov_b32 s7, 8192
    buffer_load_dword v76, v66, s[60:63], s7 offen sc1
    s_mov_b32 s7, 10240
    buffer_load_dword v77, v66, s[60:63], s7 offen sc1
    s_mov_b32 s7, 12288
    buffer_load_dword v78, v66, s[60:63], s7 offen sc1
    s_mov_b32 s7, 14336
    buffer_load_dword v79, v66, s[60:63], s7 offen sc1
    buffer_load_dwordx4 v[80:83], v67, s[60:63], 0 offen offset:0 sc1
    buffer_load_dwordx4 v[84:87], v67, s[60:63], 0 offen offset:16 sc1
    buffer_load_dwordx4 v[88:91], v67, s[60:63], 0 offen offset:32 sc1
    buffer_load_dwordx4 v[92:95], v67, s[60:63], 0 offen offset:48 sc1
    v_mov_b32 v103, 0
    ds_read_b128 v[104:107], v103 offset:8192
    s_waitcnt lgkmcnt(0)
    v_add_f32 v104, v104, v105
    v_add_f32 v106, v106, v107
    v_add_f32 v122, v104, v106
    v_cvt_pk_bf16_f32 v122, v122, v122
    v_lshlrev_b32 v122, 16, v122
    v_mul_f32 v122, s10, v122
    v_sub_f32 v122, 0, v122
    v_exp_f32 v122, v122
    s_nop 0
    v_add_f32 v122, 1.0, v122
    v_rcp_f32 v122, v122
    s_nop 0
    v_cvt_pk_bf16_f32 v122, v122, v122
    v_lshlrev_b32 v122, 16, v122
    v_sub_f32 v123, 1.0, v122
    v_cvt_pk_bf16_f32 v123, v123, v123
    v_lshlrev_b32 v123, 16, v123
    s_mov_b32 s44, s36
    s_and_b32 s45, s37, 0xffff
    s_mov_b32 s46, 4096
    s_mov_b32 s47, 0x20000
    s_lshl_b32 s14, s5, 10
    s_lshl_b32 s15, s4, 6
    s_add_u32 s14, s14, s15
    v_lshlrev_b32 v124, 1, v64
    v_add_u32 v124, s14, v124
    v_lshlrev_b32 v125, 2, v0
    v_lshlrev_b32 v126, 2, v64
L_dcheck:
    s_waitcnt vmcnt(0)
    v_max_u32 v102, v72, v73
    v_max3_u32 v102, v102, v74, v75
    v_max3_u32 v102, v102, v76, v77
    v_max3_u32 v102, v102, v78, v79
    v_max3_u32 v102, v102, v80, v81
    v_max3_u32 v102, v102, v82, v83
    v_max3_u32 v102, v102, v84, v85
    v_max3_u32 v102, v102, v86, v87
    v_max3_u32 v102, v102, v88, v89
    v_max3_u32 v102, v102, v90, v91
    v_max3_u32 v102, v102, v92, v93
    v_max3_u32 v102, v102, v94, v95
    v_cmp_eq_u32 vcc, -1, v102
    s_cbranch_vccz L_dok
    s_add_u32 s43, s43, 1
    s_cmp_ge_u32 s43, 262144
    s_cbranch_scc1 L_fin
    s_mov_b64 exec, vcc
    s_mov_b32 s7, 0
    buffer_load_dword v72, v66, s[60:63], s7 offen sc1
    s_mov_b32 s7, 2048
    buffer_load_dword v73, v66, s[60:63], s7 offen sc1
    s_mov_b32 s7, 4096
    buffer_load_dword v74, v66, s[60:63], s7 offen sc1
    s_mov_b32 s7, 6144
    buffer_load_dword v75, v66, s[60:63], s7 offen sc1
    s_mov_b32 s7, 8192
    buffer_load_dword v76, v66, s[60:63], s7 offen sc1
    s_mov_b32 s7, 10240
    buffer_load_dword v77, v66, s[60:63], s7 offen sc1
    s_mov_b32 s7, 12288
    buffer_load_dword v78, v66, s[60:63], s7 offen sc1
    s_mov_b32 s7, 14336
    buffer_load_dword v79, v66, s[60:63], s7 offen sc1
    buffer_load_dwordx4 v[80:83], v67, s[60:63], 0 offen offset:0 sc1
    buffer_load_dwordx4 v[84:87], v67, s[60:63], 0 offen offset:16 sc1
    buffer_load_dwordx4 v[88:91], v67, s[60:63], 0 offen offset:32 sc1
    buffer_load_dwordx4 v[92:95], v67, s[60:63], 0 offen offset:48 sc1
    s_branch L_dcheck
L_dok:
    s_mov_b64 exec, -1
    v_mov_b32 v100, 0
    v_max_f32 v102, v80, v82
    v_sub_f32 v80, v80, v102
    v_sub_f32 v82, v82, v102
    v_mul_f32 v80, s10, v80
    v_mul_f32 v82, s10, v82
    v_exp_f32 v80, v80
    v_exp_f32 v82, v82
    v_mul_f32 v102, v80, v81
    v_fma_f32 v102, v82, v83, v102
    v_rcp_f32 v102, v102
    v_mul_f32 v104, v80, v72
    v_fma_f32 v104, v82, v73, v104
    v_fma_f32 v100, v104, v102, v100
    v_max_f32 v102, v84, v86
    v_sub_f32 v84, v84, v102
    v_sub_f32 v86, v86, v102
    v_mul_f32 v84, s10, v84
    v_mul_f32 v86, s10, v86
    v_exp_f32 v84, v84
    v_exp_f32 v86, v86
    v_mul_f32 v102, v84, v85
    v_fma_f32 v102, v86, v87, v102
    v_rcp_f32 v102, v102
    v_mul_f32 v104, v84, v74
    v_fma_f32 v104, v86, v75, v104
    v_fma_f32 v100, v104, v102, v100
    v_max_f32 v102, v88, v90
    v_sub_f32 v88, v88, v102
    v_sub_f32 v90, v90, v102
    v_mul_f32 v88, s10, v88
    v_mul_f32 v90, s10, v90
    v_exp_f32 v88, v88
    v_exp_f32 v90, v90
    v_mul_f32 v102, v88, v89
    v_fma_f32 v102, v90, v91, v102
    v_rcp_f32 v102, v102
    v_mul_f32 v104, v88, v76
    v_fma_f32 v104, v90, v77, v104
    v_fma_f32 v100, v104, v102, v100
    v_max_f32 v102, v92, v94
    v_sub_f32 v92, v92, v102
    v_sub_f32 v94, v94, v102
    v_mul_f32 v92, s10, v92
    v_mul_f32 v94, s10, v94
    v_exp_f32 v92, v92
    v_exp_f32 v94, v94
    v_mul_f32 v102, v92, v93
    v_fma_f32 v102, v94, v95, v102
    v_rcp_f32 v102, v102
    v_mul_f32 v104, v92, v78
    v_fma_f32 v104, v94, v79, v104
    v_fma_f32 v100, v104, v102, v100
    v_add_f32 v112, v112, v113
    v_add_f32 v114, v114, v115
    v_add_f32 v116, v116, v117
    v_add_f32 v112, v112, v114
    v_add_f32 v116, v116, v118
    v_add_f32 v101, v112, v116
    ds_write_b32 v125, v100 offset:5120
    ds_write_b32 v125, v101 offset:6144
    s_waitcnt lgkmcnt(0)
    s_barrier
    s_cmp_lg_u32 s3, 0
    s_cbranch_scc1 L_fin
    ds_read_b32 v72, v126 offset:5120
    ds_read_b32 v80, v126 offset:6144
    ds_read_b32 v73, v126 offset:5248
    ds_read_b32 v81, v126 offset:6272
    ds_read_b32 v74, v126 offset:5376
    ds_read_b32 v82, v126 offset:6400
    ds_read_b32 v75, v126 offset:5504
    ds_read_b32 v83, v126 offset:6528
    ds_read_b32 v76, v126 offset:5632
    ds_read_b32 v84, v126 offset:6656
    ds_read_b32 v77, v126 offset:5760
    ds_read_b32 v85, v126 offset:6784
    ds_read_b32 v78, v126 offset:5888
    ds_read_b32 v86, v126 offset:6912
    ds_read_b32 v79, v126 offset:6016
    ds_read_b32 v87, v126 offset:7040
    s_waitcnt lgkmcnt(0)
    v_add_f32 v72, v72, v73
    v_add_f32 v80, v80, v81
    v_add_f32 v74, v74, v75
    v_add_f32 v82, v82, v83
    v_add_f32 v76, v76, v77
    v_add_f32 v84, v84, v85
    v_add_f32 v78, v78, v79
    v_add_f32 v86, v86, v87
    v_add_f32 v72, v72, v74
    v_add_f32 v80, v80, v82
    v_add_f32 v76, v76, v78
    v_add_f32 v84, v84, v86
    v_add_f32 v72, v72, v76
    v_add_f32 v80, v80, v84
    v_cvt_pk_bf16_f32 v106, v72, v80
    v_lshlrev_b32 v107, 16, v106
    v_and_b32 v106, s68, v106
    v_mul_f32 v107, v122, v107
    v_mul_f32 v106, v123, v106
    v_cvt_pk_bf16_f32 v106, v107, v106
    v_lshlrev_b32 v107, 16, v106
    v_and_b32 v106, s68, v106
    v_add_f32 v106, v106, v107
    v_cvt_pk_bf16_f32 v106, v106, v106
    s_mov_b64 exec, 0xffffffff
    buffer_store_short v106, v124, s[44:47], 0 offen
    s_mov_b64 exec, -1
    s_branch L_fin
L_keeper:
    v_lshlrev_b32 v64, 3, v0
    v_add_u32 v64, 590848, v64
    v_and_b32 v65, 63, v0
    v_min_u32 v65, 55, v65
    v_lshrrev_b32 v66, 6, v0
    v_lshlrev_b32 v66, 9, v66
    v_lshl_add_u32 v65, v65, 3, v66
    v_add_u32 v65, 598016, v65
    s_mov_b32 s43, 0
L_kpoll:
    buffer_load_dwordx2 v[68:69], v64, s[60:63], 0 offen sc1
    buffer_load_dwordx2 v[70:71], v65, s[60:63], 0 offen sc1
    s_waitcnt vmcnt(0)
    v_cmp_ne_u64 vcc, s[90:91], v[68:69]
    s_mov_b64 s[14:15], vcc
    v_cmp_ne_u64 vcc, s[90:91], v[70:71]
    s_or_b64 s[14:15], s[14:15], vcc
    s_cmp_eq_u64 s[14:15], 0
    s_cbranch_scc1 L_kok
    s_add_u32 s43, s43, 1
    s_cmp_ge_u32 s43, 262144
    s_cbranch_scc1 L_fin
    s_sleep 64
    s_branch L_kpoll
L_kok:
    s_barrier
    s_cmp_lg_u32 s3, 0
    s_cbranch_scc1 L_fin
    v_mov_b32 v64, 589824
    v_mov_b32 v68, s90
    v_mov_b32 v69, s91
    s_mov_b64 exec, 1
    buffer_store_dwordx2 v[68:69], v64, s[60:63], 0 offen sc1
    s_mov_b64 exec, -1
    s_branch L_fin
L_proj:
    v_and_b32_dpp v32, v50, v4 row_newbcast:0 row_mask:0xf bank_mask:0xf
    v_and_b32_dpp v33, v50, v5 row_newbcast:0 row_mask:0xf bank_mask:0xf
    v_and_b32_dpp v34, v50, v6 row_newbcast:0 row_mask:0xf bank_mask:0xf
    v_and_b32_dpp v35, v50, v7 row_newbcast:0 row_mask:0xf bank_mask:0xf
    v_and_b32_dpp v36, v50, v4 row_newbcast:1 row_mask:0xf bank_mask:0xf
    v_and_b32_dpp v37, v50, v5 row_newbcast:1 row_mask:0xf bank_mask:0xf
    v_and_b32_dpp v38, v50, v6 row_newbcast:1 row_mask:0xf bank_mask:0xf
    v_and_b32_dpp v39, v50, v7 row_newbcast:1 row_mask:0xf bank_mask:0xf
    v_mfma_f32_16x16x32_bf16 v[12:15], v[32:35], v[128:131], v[12:15]
    v_and_b32_dpp v32, v50, v4 row_newbcast:2 row_mask:0xf bank_mask:0xf
    v_and_b32_dpp v33, v50, v5 row_newbcast:2 row_mask:0xf bank_mask:0xf
    v_and_b32_dpp v34, v50, v6 row_newbcast:2 row_mask:0xf bank_mask:0xf
    v_and_b32_dpp v35, v50, v7 row_newbcast:2 row_mask:0xf bank_mask:0xf
    v_mfma_f32_16x16x32_bf16 v[18:21], v[36:39], v[132:135], 0
    v_and_b32_dpp v36, v50, v4 row_newbcast:3 row_mask:0xf bank_mask:0xf
    v_and_b32_dpp v37, v50, v5 row_newbcast:3 row_mask:0xf bank_mask:0xf
    v_and_b32_dpp v38, v50, v6 row_newbcast:3 row_mask:0xf bank_mask:0xf
    v_and_b32_dpp v39, v50, v7 row_newbcast:3 row_mask:0xf bank_mask:0xf
    v_mfma_f32_16x16x32_bf16 v[12:15], v[32:35], v[136:139], v[12:15]
    v_and_b32_dpp v32, v50, v4 row_newbcast:4 row_mask:0xf bank_mask:0xf
    v_and_b32_dpp v33, v50, v5 row_newbcast:4 row_mask:0xf bank_mask:0xf
    v_and_b32_dpp v34, v50, v6 row_newbcast:4 row_mask:0xf bank_mask:0xf
    v_and_b32_dpp v35, v50, v7 row_newbcast:4 row_mask:0xf bank_mask:0xf
    v_mfma_f32_16x16x32_bf16 v[18:21], v[36:39], v[140:143], v[18:21]
    v_and_b32_dpp v36, v50, v4 row_newbcast:5 row_mask:0xf bank_mask:0xf
    v_and_b32_dpp v37, v50, v5 row_newbcast:5 row_mask:0xf bank_mask:0xf
    v_and_b32_dpp v38, v50, v6 row_newbcast:5 row_mask:0xf bank_mask:0xf
    v_and_b32_dpp v39, v50, v7 row_newbcast:5 row_mask:0xf bank_mask:0xf
    v_mfma_f32_16x16x32_bf16 v[12:15], v[32:35], v[144:147], v[12:15]
    v_and_b32_dpp v32, v50, v4 row_newbcast:6 row_mask:0xf bank_mask:0xf
    v_and_b32_dpp v33, v50, v5 row_newbcast:6 row_mask:0xf bank_mask:0xf
    v_and_b32_dpp v34, v50, v6 row_newbcast:6 row_mask:0xf bank_mask:0xf
    v_and_b32_dpp v35, v50, v7 row_newbcast:6 row_mask:0xf bank_mask:0xf
    v_mfma_f32_16x16x32_bf16 v[18:21], v[36:39], v[148:151], v[18:21]
    v_and_b32_dpp v36, v50, v4 row_newbcast:7 row_mask:0xf bank_mask:0xf
    v_and_b32_dpp v37, v50, v5 row_newbcast:7 row_mask:0xf bank_mask:0xf
    v_and_b32_dpp v38, v50, v6 row_newbcast:7 row_mask:0xf bank_mask:0xf
    v_and_b32_dpp v39, v50, v7 row_newbcast:7 row_mask:0xf bank_mask:0xf
    v_mfma_f32_16x16x32_bf16 v[12:15], v[32:35], v[152:155], v[12:15]
    v_and_b32_dpp v32, v50, v4 row_newbcast:8 row_mask:0xf bank_mask:0xf
    v_and_b32_dpp v33, v50, v5 row_newbcast:8 row_mask:0xf bank_mask:0xf
    v_and_b32_dpp v34, v50, v6 row_newbcast:8 row_mask:0xf bank_mask:0xf
    v_and_b32_dpp v35, v50, v7 row_newbcast:8 row_mask:0xf bank_mask:0xf
    v_mfma_f32_16x16x32_bf16 v[18:21], v[36:39], v[156:159], v[18:21]
    v_and_b32_dpp v36, v50, v4 row_newbcast:9 row_mask:0xf bank_mask:0xf
    v_and_b32_dpp v37, v50, v5 row_newbcast:9 row_mask:0xf bank_mask:0xf
    v_and_b32_dpp v38, v50, v6 row_newbcast:9 row_mask:0xf bank_mask:0xf
    v_and_b32_dpp v39, v50, v7 row_newbcast:9 row_mask:0xf bank_mask:0xf
    v_mfma_f32_16x16x32_bf16 v[12:15], v[32:35], v[160:163], v[12:15]
    v_and_b32_dpp v32, v50, v4 row_newbcast:10 row_mask:0xf bank_mask:0xf
    v_and_b32_dpp v33, v50, v5 row_newbcast:10 row_mask:0xf bank_mask:0xf
    v_and_b32_dpp v34, v50, v6 row_newbcast:10 row_mask:0xf bank_mask:0xf
    v_and_b32_dpp v35, v50, v7 row_newbcast:10 row_mask:0xf bank_mask:0xf
    v_mfma_f32_16x16x32_bf16 v[18:21], v[36:39], v[164:167], v[18:21]
    v_and_b32_dpp v36, v50, v4 row_newbcast:11 row_mask:0xf bank_mask:0xf
    v_and_b32_dpp v37, v50, v5 row_newbcast:11 row_mask:0xf bank_mask:0xf
    v_and_b32_dpp v38, v50, v6 row_newbcast:11 row_mask:0xf bank_mask:0xf
    v_and_b32_dpp v39, v50, v7 row_newbcast:11 row_mask:0xf bank_mask:0xf
    v_mfma_f32_16x16x32_bf16 v[12:15], v[32:35], v[168:171], v[12:15]
    v_and_b32_dpp v32, v50, v4 row_newbcast:12 row_mask:0xf bank_mask:0xf
    v_and_b32_dpp v33, v50, v5 row_newbcast:12 row_mask:0xf bank_mask:0xf
    v_and_b32_dpp v34, v50, v6 row_newbcast:12 row_mask:0xf bank_mask:0xf
    v_and_b32_dpp v35, v50, v7 row_newbcast:12 row_mask:0xf bank_mask:0xf
    v_mfma_f32_16x16x32_bf16 v[18:21], v[36:39], v[172:175], v[18:21]
    v_and_b32_dpp v36, v50, v4 row_newbcast:13 row_mask:0xf bank_mask:0xf
    v_and_b32_dpp v37, v50, v5 row_newbcast:13 row_mask:0xf bank_mask:0xf
    v_and_b32_dpp v38, v50, v6 row_newbcast:13 row_mask:0xf bank_mask:0xf
    v_and_b32_dpp v39, v50, v7 row_newbcast:13 row_mask:0xf bank_mask:0xf
    v_mfma_f32_16x16x32_bf16 v[12:15], v[32:35], v[176:179], v[12:15]
    v_and_b32_dpp v32, v50, v4 row_newbcast:14 row_mask:0xf bank_mask:0xf
    v_and_b32_dpp v33, v50, v5 row_newbcast:14 row_mask:0xf bank_mask:0xf
    v_and_b32_dpp v34, v50, v6 row_newbcast:14 row_mask:0xf bank_mask:0xf
    v_and_b32_dpp v35, v50, v7 row_newbcast:14 row_mask:0xf bank_mask:0xf
    v_mfma_f32_16x16x32_bf16 v[18:21], v[36:39], v[180:183], v[18:21]
    v_and_b32_dpp v36, v50, v4 row_newbcast:15 row_mask:0xf bank_mask:0xf
    v_and_b32_dpp v37, v50, v5 row_newbcast:15 row_mask:0xf bank_mask:0xf
    v_and_b32_dpp v38, v50, v6 row_newbcast:15 row_mask:0xf bank_mask:0xf
    v_and_b32_dpp v39, v50, v7 row_newbcast:15 row_mask:0xf bank_mask:0xf
    v_mfma_f32_16x16x32_bf16 v[12:15], v[32:35], v[184:187], v[12:15]
    v_and_b32_dpp v32, v51, v4 row_newbcast:0 row_mask:0xf bank_mask:0xf
    v_and_b32_dpp v33, v51, v5 row_newbcast:0 row_mask:0xf bank_mask:0xf
    v_and_b32_dpp v34, v51, v6 row_newbcast:0 row_mask:0xf bank_mask:0xf
    v_and_b32_dpp v35, v51, v7 row_newbcast:0 row_mask:0xf bank_mask:0xf
    v_mfma_f32_16x16x32_bf16 v[18:21], v[36:39], v[188:191], v[18:21]
    v_and_b32_dpp v36, v51, v4 row_newbcast:1 row_mask:0xf bank_mask:0xf
    v_and_b32_dpp v37, v51, v5 row_newbcast:1 row_mask:0xf bank_mask:0xf
    v_and_b32_dpp v38, v51, v6 row_newbcast:1 row_mask:0xf bank_mask:0xf
    v_and_b32_dpp v39, v51, v7 row_newbcast:1 row_mask:0xf bank_mask:0xf
    v_mfma_f32_16x16x32_bf16 v[12:15], v[32:35], v[192:195], v[12:15]
    v_and_b32_dpp v32, v51, v4 row_newbcast:2 row_mask:0xf bank_mask:0xf
    v_and_b32_dpp v33, v51, v5 row_newbcast:2 row_mask:0xf bank_mask:0xf
    v_and_b32_dpp v34, v51, v6 row_newbcast:2 row_mask:0xf bank_mask:0xf
    v_and_b32_dpp v35, v51, v7 row_newbcast:2 row_mask:0xf bank_mask:0xf
    v_mfma_f32_16x16x32_bf16 v[18:21], v[36:39], v[196:199], v[18:21]
    v_and_b32_dpp v36, v51, v4 row_newbcast:3 row_mask:0xf bank_mask:0xf
    v_and_b32_dpp v37, v51, v5 row_newbcast:3 row_mask:0xf bank_mask:0xf
    v_and_b32_dpp v38, v51, v6 row_newbcast:3 row_mask:0xf bank_mask:0xf
    v_and_b32_dpp v39, v51, v7 row_newbcast:3 row_mask:0xf bank_mask:0xf
    v_mfma_f32_16x16x32_bf16 v[12:15], v[32:35], v[200:203], v[12:15]
    v_and_b32_dpp v32, v51, v4 row_newbcast:4 row_mask:0xf bank_mask:0xf
    v_and_b32_dpp v33, v51, v5 row_newbcast:4 row_mask:0xf bank_mask:0xf
    v_and_b32_dpp v34, v51, v6 row_newbcast:4 row_mask:0xf bank_mask:0xf
    v_and_b32_dpp v35, v51, v7 row_newbcast:4 row_mask:0xf bank_mask:0xf
    v_mfma_f32_16x16x32_bf16 v[18:21], v[36:39], v[204:207], v[18:21]
    v_and_b32_dpp v36, v51, v4 row_newbcast:5 row_mask:0xf bank_mask:0xf
    v_and_b32_dpp v37, v51, v5 row_newbcast:5 row_mask:0xf bank_mask:0xf
    v_and_b32_dpp v38, v51, v6 row_newbcast:5 row_mask:0xf bank_mask:0xf
    v_and_b32_dpp v39, v51, v7 row_newbcast:5 row_mask:0xf bank_mask:0xf
    v_mfma_f32_16x16x32_bf16 v[12:15], v[32:35], v[208:211], v[12:15]
    v_and_b32_dpp v32, v51, v4 row_newbcast:6 row_mask:0xf bank_mask:0xf
    v_and_b32_dpp v33, v51, v5 row_newbcast:6 row_mask:0xf bank_mask:0xf
    v_and_b32_dpp v34, v51, v6 row_newbcast:6 row_mask:0xf bank_mask:0xf
    v_and_b32_dpp v35, v51, v7 row_newbcast:6 row_mask:0xf bank_mask:0xf
    v_mfma_f32_16x16x32_bf16 v[18:21], v[36:39], v[212:215], v[18:21]
    v_and_b32_dpp v36, v51, v4 row_newbcast:7 row_mask:0xf bank_mask:0xf
    v_and_b32_dpp v37, v51, v5 row_newbcast:7 row_mask:0xf bank_mask:0xf
    v_and_b32_dpp v38, v51, v6 row_newbcast:7 row_mask:0xf bank_mask:0xf
    v_and_b32_dpp v39, v51, v7 row_newbcast:7 row_mask:0xf bank_mask:0xf
    v_mfma_f32_16x16x32_bf16 v[12:15], v[32:35], v[216:219], v[12:15]
    v_and_b32_dpp v32, v51, v4 row_newbcast:8 row_mask:0xf bank_mask:0xf
    v_and_b32_dpp v33, v51, v5 row_newbcast:8 row_mask:0xf bank_mask:0xf
    v_and_b32_dpp v34, v51, v6 row_newbcast:8 row_mask:0xf bank_mask:0xf
    v_and_b32_dpp v35, v51, v7 row_newbcast:8 row_mask:0xf bank_mask:0xf
    v_mfma_f32_16x16x32_bf16 v[18:21], v[36:39], v[220:223], v[18:21]
    v_and_b32_dpp v36, v51, v4 row_newbcast:9 row_mask:0xf bank_mask:0xf
    v_and_b32_dpp v37, v51, v5 row_newbcast:9 row_mask:0xf bank_mask:0xf
    v_and_b32_dpp v38, v51, v6 row_newbcast:9 row_mask:0xf bank_mask:0xf
    v_and_b32_dpp v39, v51, v7 row_newbcast:9 row_mask:0xf bank_mask:0xf
    v_mfma_f32_16x16x32_bf16 v[12:15], v[32:35], v[224:227], v[12:15]
    v_and_b32_dpp v32, v51, v4 row_newbcast:10 row_mask:0xf bank_mask:0xf
    v_and_b32_dpp v33, v51, v5 row_newbcast:10 row_mask:0xf bank_mask:0xf
    v_and_b32_dpp v34, v51, v6 row_newbcast:10 row_mask:0xf bank_mask:0xf
    v_and_b32_dpp v35, v51, v7 row_newbcast:10 row_mask:0xf bank_mask:0xf
    v_mfma_f32_16x16x32_bf16 v[18:21], v[36:39], v[228:231], v[18:21]
    v_and_b32_dpp v36, v51, v4 row_newbcast:11 row_mask:0xf bank_mask:0xf
    v_and_b32_dpp v37, v51, v5 row_newbcast:11 row_mask:0xf bank_mask:0xf
    v_and_b32_dpp v38, v51, v6 row_newbcast:11 row_mask:0xf bank_mask:0xf
    v_and_b32_dpp v39, v51, v7 row_newbcast:11 row_mask:0xf bank_mask:0xf
    v_mfma_f32_16x16x32_bf16 v[12:15], v[32:35], v[232:235], v[12:15]
    v_and_b32_dpp v32, v51, v4 row_newbcast:12 row_mask:0xf bank_mask:0xf
    v_and_b32_dpp v33, v51, v5 row_newbcast:12 row_mask:0xf bank_mask:0xf
    v_and_b32_dpp v34, v51, v6 row_newbcast:12 row_mask:0xf bank_mask:0xf
    v_and_b32_dpp v35, v51, v7 row_newbcast:12 row_mask:0xf bank_mask:0xf
    v_mfma_f32_16x16x32_bf16 v[18:21], v[36:39], v[236:239], v[18:21]
    v_and_b32_dpp v36, v51, v4 row_newbcast:13 row_mask:0xf bank_mask:0xf
    v_and_b32_dpp v37, v51, v5 row_newbcast:13 row_mask:0xf bank_mask:0xf
    v_and_b32_dpp v38, v51, v6 row_newbcast:13 row_mask:0xf bank_mask:0xf
    v_and_b32_dpp v39, v51, v7 row_newbcast:13 row_mask:0xf bank_mask:0xf
    v_mfma_f32_16x16x32_bf16 v[12:15], v[32:35], v[240:243], v[12:15]
    v_and_b32_dpp v32, v51, v4 row_newbcast:14 row_mask:0xf bank_mask:0xf
    v_and_b32_dpp v33, v51, v5 row_newbcast:14 row_mask:0xf bank_mask:0xf
    v_and_b32_dpp v34, v51, v6 row_newbcast:14 row_mask:0xf bank_mask:0xf
    v_and_b32_dpp v35, v51, v7 row_newbcast:14 row_mask:0xf bank_mask:0xf
    v_mfma_f32_16x16x32_bf16 v[18:21], v[36:39], v[244:247], v[18:21]
    v_and_b32_dpp v36, v51, v4 row_newbcast:15 row_mask:0xf bank_mask:0xf
    v_and_b32_dpp v37, v51, v5 row_newbcast:15 row_mask:0xf bank_mask:0xf
    v_and_b32_dpp v38, v51, v6 row_newbcast:15 row_mask:0xf bank_mask:0xf
    v_and_b32_dpp v39, v51, v7 row_newbcast:15 row_mask:0xf bank_mask:0xf
    v_mfma_f32_16x16x32_bf16 v[12:15], v[32:35], v[248:251], v[12:15]
    s_nop 0
    v_mfma_f32_16x16x32_bf16 v[18:21], v[36:39], v[252:255], v[18:21]
    s_nop 7
    v_add_f32 v12, v12, v18
    v_add_f32 v13, v13, v19
    v_add_f32 v14, v14, v20
    v_add_f32 v15, v15, v21
    s_setpc_b64 s[12:13]
L_ffn:
    s_setprio 3
    s_mov_b32 s10, 0x3fb8aa3b
    s_mov_b32 s11, 0x3db504f3
    s_mov_b32 s68, 0xffff0000
    v_and_b32 v45, 1, v1
    v_lshlrev_b32 v45, 4, v45
    v_mov_b32 v46, 0xffff
    v_lshlrev_b32 v46, v45, v46
    v_bfe_u32 v47, v1, 1, 3
    v_cmp_eq_u32 vcc, 0, v47
    s_nop 1
    v_cndmask_b32 v4, 0, v46, vcc
    v_cmp_eq_u32 vcc, 1, v47
    s_nop 1
    v_cndmask_b32 v5, 0, v46, vcc
    v_cmp_eq_u32 vcc, 2, v47
    s_nop 1
    v_cndmask_b32 v6, 0, v46, vcc
    v_cmp_eq_u32 vcc, 3, v47
    s_nop 1
    v_cndmask_b32 v7, 0, v46, vcc
    s_waitcnt lgkmcnt(0)
    s_load_dwordx2 s[90:91], s[40:41], 0x90000
    s_sub_u32 s4, s2, 256
    s_lshr_b32 s5, s4, 4
    s_and_b32 s6, s4, 15
    s_mov_b32 s56, s16
    s_and_b32 s57, s17, 0xffff
    s_mov_b32 s58, 4096
    s_mov_b32 s59, 0x20000
    s_and_b32 s14, s6, 7
    s_lshl_b32 s14, s14, 6
    s_lshl_b32 s15, s3, 4
    s_add_u32 s14, s14, s15
    v_lshl_add_u32 v45, v44, 2, s14
    v_and_b32 v40, 3, v1
    v_add_u32 v40, v40, v45
    v_lshlrev_b32 v40, 1, v40
    v_bfe_u32 v41, v1, 2, 2
    v_lshl_add_u32 v40, v41, 10, v40
    buffer_load_ushort v22, v40, s[56:59], 0 offen
    s_cmp_lt_u32 s6, 8
    s_cselect_b32 s44, s28, s30
    s_cselect_b32 s45, s29, s31
    s_lshl_b32 s14, s5, 8
    s_add_u32 s44, s44, s14
    s_addc_u32 s45, s45, 0
    s_and_b32 s45, s45, 0xffff
    s_sub_u32 s46, 1835008, s14
    s_mov_b32 s47, 0x20000
    v_mul_u32_u24 v20, 3584, v45
    v_add_u32 v20, v20, v43
    s_mov_b32 s7, 0
    buffer_load_dwordx4 v[64:67], v20, s[44:47], s7 offen nt
    s_mov_b32 s7, 3584
    buffer_load_dwordx4 v[68:71], v20, s[44:47], s7 offen nt
    s_mov_b32 s7, 7168
    buffer_load_dwordx4 v[72:75], v20, s[44:47], s7 offen nt
    s_mov_b32 s7, 10752
    buffer_load_dwordx4 v[76:79], v20, s[44:47], s7 offen nt
    s_mov_b32 s52, s32
    s_and_b32 s53, s33, 0xffff
    s_mov_b32 s54, 1835008
    s_mov_b32 s55, 0x20000
    s_lshl_b32 s14, s5, 7
    s_lshr_b32 s15, s6, 2
    s_lshl_b32 s15, s15, 5
    s_add_u32 s14, s14, s15
    s_lshl_b32 s15, s3, 3
    s_add_u32 s14, s14, s15
    v_lshl_add_u32 v48, v44, 1, s14
    v_lshlrev_b32 v48, 10, v48
    s_and_b32 s14, s6, 3
    s_lshl_b32 s14, s14, 8
    v_add3_u32 v48, v48, v43, s14
    buffer_load_dwordx4 v[96:99], v48, s[52:55], 0 offen offset:0 nt
    buffer_load_dwordx4 v[100:103], v48, s[52:55], 0 offen offset:1024 nt
    v_and_b32 v45, 8, v1
    v_mov_b32 v46, 0x0100
    v_mov_b32 v47, 0x0302
    v_cmp_eq_u32 vcc, 0, v45
    s_nop 1
    v_cndmask_b32 v46, v47, v46, vcc
    v_lshlrev_b32 v47, 16, v46
    v_or_b32 v47, 0x0c0c, v47
    v_or_b32 v46, 0x0c0c0000, v46
    v_and_b32 v45, 1, v1
    v_cmp_eq_u32 vcc, 0, v45
    s_nop 1
    v_cndmask_b32 v46, v47, v46, vcc
    v_bfe_u32 v45, v1, 1, 2
    v_mov_b32 v47, 0x0c0c0c0c
    v_cmp_eq_u32 vcc, 0, v45
    s_nop 1
    v_cndmask_b32 v4, v47, v46, vcc
    v_cmp_eq_u32 vcc, 1, v45
    s_nop 1
    v_cndmask_b32 v5, v47, v46, vcc
    v_cmp_eq_u32 vcc, 2, v45
    s_nop 1
    v_cndmask_b32 v6, v47, v46, vcc
    v_cmp_eq_u32 vcc, 3, v45
    s_nop 1
    v_cndmask_b32 v7, v47, v46, vcc
    s_mov_b32 s60, s40
    s_and_b32 s61, s41, 0xffff
    s_mov_b32 s62, 2097152
    s_mov_b32 s63, 0x20000
    s_lshr_b32 s14, s3, 1
    s_lshl_b32 s14, s14, 10
    s_and_b32 s15, s3, 1
    s_lshl_b32 s15, s15, 9
    s_add_u32 s14, s14, s15
    v_bfe_u32 v54, v1, 1, 1
    v_lshlrev_b32 v54, 8, v54
    v_lshrrev_b32 v45, 2, v1
    v_lshl_add_u32 v54, v45, 4, v54
    v_and_b32 v45, 1, v1
    v_lshl_add_u32 v54, v45, 3, v54
    v_add_u32 v54, s14, v54
    s_waitcnt vmcnt(6)
    v_mov_b32_dpp v23, v22 row_shl:4 row_mask:0xf bank_mask:0xf bound_ctrl:0
    v_lshl_or_b32 v50, v23, 16, v22
    v_mov_b32 v12, 0
    v_mov_b32 v13, 0
    v_mov_b32 v14, 0
    v_mov_b32 v15, 0
    v_mov_b32 v16, 0
    v_mov_b32 v17, 0
    v_mov_b32 v18, 0
    v_mov_b32 v19, 0
    v_mov_b32_dpp v30, v50 row_newbcast:0 row_mask:0xf bank_mask:0xf
    v_mov_b32_dpp v31, v50 row_newbcast:8 row_mask:0xf bank_mask:0xf
    v_perm_b32 v32, v30, v30, v4
    v_perm_b32 v33, v30, v30, v5
    v_perm_b32 v34, v30, v30, v6
    v_perm_b32 v35, v30, v30, v7
    v_perm_b32 v36, v31, v31, v4
    v_perm_b32 v37, v31, v31, v5
    v_perm_b32 v38, v31, v31, v6
    v_perm_b32 v39, v31, v31, v7
    s_waitcnt vmcnt(5)
    v_mfma_f32_16x16x32_bf16 v[12:15], v[32:35], v[64:67], v[12:15]
    v_mfma_f32_16x16x32_bf16 v[16:19], v[36:39], v[64:67], v[16:19]
    v_mov_b32_dpp v30, v50 row_newbcast:1 row_mask:0xf bank_mask:0xf
    v_mov_b32_dpp v31, v50 row_newbcast:9 row_mask:0xf bank_mask:0xf
    v_perm_b32 v32, v30, v30, v4
    v_perm_b32 v33, v30, v30, v5
    v_perm_b32 v34, v30, v30, v6
    v_perm_b32 v35, v30, v30, v7
    v_perm_b32 v36, v31, v31, v4
    v_perm_b32 v37, v31, v31, v5
    v_perm_b32 v38, v31, v31, v6
    v_perm_b32 v39, v31, v31, v7
    s_waitcnt vmcnt(4)
    v_mfma_f32_16x16x32_bf16 v[12:15], v[32:35], v[68:71], v[12:15]
    v_mfma_f32_16x16x32_bf16 v[16:19], v[36:39], v[68:71], v[16:19]
    v_mov_b32_dpp v30, v50 row_newbcast:2 row_mask:0xf bank_mask:0xf
    v_mov_b32_dpp v31, v50 row_newbcast:10 row_mask:0xf bank_mask:0xf
    v_perm_b32 v32, v30, v30, v4
    v_perm_b32 v33, v30, v30, v5
    v_perm_b32 v34, v30, v30, v6
    v_perm_b32 v35, v30, v30, v7
    v_perm_b32 v36, v31, v31, v4
    v_perm_b32 v37, v31, v31, v5
    v_perm_b32 v38, v31, v31, v6
    v_perm_b32 v39, v31, v31, v7
    s_waitcnt vmcnt(3)
    v_mfma_f32_16x16x32_bf16 v[12:15], v[32:35], v[72:75], v[12:15]
    v_mfma_f32_16x16x32_bf16 v[16:19], v[36:39], v[72:75], v[16:19]
    v_mov_b32_dpp v30, v50 row_newbcast:3 row_mask:0xf bank_mask:0xf
    v_mov_b32_dpp v31, v50 row_newbcast:11 row_mask:0xf bank_mask:0xf
    v_perm_b32 v32, v30, v30, v4
    v_perm_b32 v33, v30, v30, v5
    v_perm_b32 v34, v30, v30, v6
    v_perm_b32 v35, v30, v30, v7
    v_perm_b32 v36, v31, v31, v4
    v_perm_b32 v37, v31, v31, v5
    v_perm_b32 v38, v31, v31, v6
    v_perm_b32 v39, v31, v31, v7
    s_waitcnt vmcnt(2)
    v_mfma_f32_16x16x32_bf16 v[12:15], v[32:35], v[76:79], v[12:15]
    v_mfma_f32_16x16x32_bf16 v[16:19], v[36:39], v[76:79], v[16:19]
    s_lshl_b32 s14, s3, 11
    v_lshlrev_b32 v40, 4, v1
    v_add_u32 v40, s14, v40
    s_nop 3
    ds_write_b128 v40, v[12:15]
    ds_write_b128 v40, v[16:19] offset:1024
    s_waitcnt lgkmcnt(0)
    s_barrier
    ds_read_b64 v[18:19], v54 offset:0
    ds_read_b64 v[20:21], v54 offset:2048
    ds_read_b64 v[22:23], v54 offset:4096
    ds_read_b64 v[24:25], v54 offset:6144
    s_waitcnt lgkmcnt(0)
    v_add_f32 v18, v18, v20
    v_add_f32 v22, v22, v24
    v_add_f32 v19, v19, v21
    v_add_f32 v23, v23, v25
    v_add_f32 v26, v18, v22
    v_add_f32 v27, v19, v23
    s_lshl_b32 s14, s4, 11
    s_lshl_b32 s15, s3, 9
    s_add_u32 s14, s14, s15
    s_add_u32 s14, s14, 1572864
    v_lshl_add_u32 v40, v1, 3, s14
    buffer_store_dwordx2 v[26:27], v40, s[60:63], 0 offen sc1
    s_lshl_b32 s14, s4, 3
    s_add_u32 s14, s14, 593920
    v_mov_b32 v41, s14
    s_add_u32 s90, s90, 1
    s_addc_u32 s91, s91, 0
    v_mov_b32 v28, s90
    v_mov_b32 v29, s91
    s_lshl_b32 s14, s5, 7
    s_add_u32 s14, s14, 593920
    v_lshl_add_u32 v42, v1, 3, s14
    s_waitcnt vmcnt(0)
    s_barrier
    s_cmp_lg_u32 s3, 0
    s_cbranch_scc1 L_f1ok
    s_mov_b64 exec, 1
    buffer_store_dwordx2 v[28:29], v41, s[60:63], 0 offen sc1
    s_mov_b64 exec, 0xffff
    s_mov_b32 s43, 0
L_f1poll:
    s_sleep 16
    buffer_load_dwordx2 v[46:47], v42, s[60:63], 0 offen sc1
    s_waitcnt vmcnt(0)
    v_cmp_ne_u64 vcc, s[90:91], v[46:47]
    s_cmp_eq_u64 vcc, 0
    s_cbranch_scc1 L_f1seen
    s_add_u32 s43, s43, 1
    s_cmp_ge_u32 s43, 262144
    s_cbranch_scc1 L_fin
    s_branch L_f1poll
L_f1seen:
    s_mov_b64 exec, -1
L_f1ok:
    s_barrier
    s_lshl_b32 s14, s5, 4
    s_lshl_b32 s15, s3, 2
    s_add_u32 s14, s14, s15
    v_lshrrev_b32 v40, 5, v1
    v_add_u32 v40, s14, v40
    v_lshlrev_b32 v40, 11, v40
    v_bfe_u32 v41, v1, 3, 2
    v_lshl_add_u32 v40, v41, 9, v40
    v_and_b32 v42, 7, v1
    v_lshl_add_u32 v40, v42, 4, v40
    s_lshr_b32 s15, s6, 2
    s_lshl_b32 s15, s15, 7
    s_add_u32 s15, s15, 1572864
    v_add_u32 v40, s15, v40
    s_mov_b32 s7, 4096
    buffer_load_dwordx4 v[112:115], v40, s[60:63], 0 offen sc1
    buffer_load_dwordx4 v[116:119], v40, s[60:63], s7 offen sc1
    s_lshl_b32 s14, s3, 11
    v_lshrrev_b32 v45, 5, v1
    v_lshlrev_b32 v45, 9, v45
    v_lshl_add_u32 v45, v41, 7, v45
    v_lshl_add_u32 v45, v42, 4, v45
    v_add_u32 v45, s14, v45
    s_waitcnt vmcnt(0)
    ds_write_b128 v45, v[112:115] offset:8192
    ds_write_b128 v45, v[116:119] offset:9216
    v_and_b32 v40, 127, v0
    v_lshlrev_b32 v40, 2, v40
    s_waitcnt lgkmcnt(0)
    s_barrier
    ds_read_b32 v64, v40 offset:8192
    ds_read_b32 v65, v40 offset:8704
    ds_read_b32 v66, v40 offset:9216
    ds_read_b32 v67, v40 offset:9728
    ds_read_b32 v68, v40 offset:10240
    ds_read_b32 v69, v40 offset:10752
    ds_read_b32 v70, v40 offset:11264
    ds_read_b32 v71, v40 offset:11776
    ds_read_b32 v72, v40 offset:12288
    ds_read_b32 v73, v40 offset:12800
    ds_read_b32 v74, v40 offset:13312
    ds_read_b32 v75, v40 offset:13824
    ds_read_b32 v76, v40 offset:14336
    ds_read_b32 v77, v40 offset:14848
    ds_read_b32 v78, v40 offset:15360
    ds_read_b32 v79, v40 offset:15872
    s_waitcnt lgkmcnt(0)
    v_add_f32 v64, v64, v65
    v_add_f32 v66, v66, v67
    v_add_f32 v68, v68, v69
    v_add_f32 v70, v70, v71
    v_add_f32 v64, v64, v66
    v_add_f32 v68, v68, v70
    v_add_f32 v64, v64, v68
    v_add_f32 v72, v72, v73
    v_add_f32 v74, v74, v75
    v_add_f32 v76, v76, v77
    v_add_f32 v78, v78, v79
    v_add_f32 v72, v72, v74
    v_add_f32 v76, v76, v78
    v_add_f32 v72, v72, v76
    v_cvt_pk_bf16_f32 v19, v64, v72
    v_lshlrev_b32 v18, 16, v19
    v_and_b32 v22, s68, v19
    v_mul_f32 v19, v18, v18
    v_mul_f32 v19, v19, v18
    v_mov_b32 v20, 0x3d372713
    v_fma_f32 v19, v19, v20, v18
    v_mul_f32 v19, 0x3f4c422a, v19
    v_mul_f32 v19, s10, v19
    v_mul_f32 v19, -2.0, v19
    v_exp_f32 v19, v19
    s_nop 0
    v_add_f32 v19, 1.0, v19
    v_rcp_f32 v19, v19
    s_nop 0
    v_mul_f32 v19, v18, v19
    v_cvt_pk_bf16_f32 v19, v19, v19
    v_lshlrev_b32 v19, 16, v19
    v_mul_f32 v19, v19, v22
    v_cvt_pk_bf16_f32 v19, v19, v19
    v_bfe_u32 v41, v0, 6, 1
    v_lshlrev_b32 v41, 7, v41
    v_and_b32 v42, 31, v0
    v_lshl_add_u32 v41, v42, 2, v41
    v_bfe_u32 v42, v0, 5, 1
    v_lshl_add_u32 v41, v42, 1, v41
    ds_write_b16 v41, v19 offset:16384
    s_lshl_b32 s14, s3, 3
    v_lshl_add_u32 v42, v44, 1, s14
    v_and_b32 v45, 1, v1
    v_add_u32 v42, v42, v45
    v_lshlrev_b32 v42, 2, v42
    s_waitcnt lgkmcnt(0)
    s_barrier
    ds_read_b32 v50, v42 offset:16384
    ds_read_b32 v51, v42 offset:16512
    v_mov_b32 v12, 0
    v_mov_b32 v13, 0
    v_mov_b32 v14, 0
    v_mov_b32 v15, 0
    v_mov_b32 v16, 0
    v_mov_b32 v17, 0
    v_mov_b32 v18, 0
    v_mov_b32 v19, 0
    s_waitcnt lgkmcnt(0)
    v_mov_b32_dpp v30, v50 row_newbcast:0 row_mask:0xf bank_mask:0xf
    v_mov_b32_dpp v31, v51 row_newbcast:0 row_mask:0xf bank_mask:0xf
    v_perm_b32 v32, v30, v30, v4
    v_perm_b32 v33, v30, v30, v5
    v_perm_b32 v34, v30, v30, v6
    v_perm_b32 v35, v30, v30, v7
    v_perm_b32 v36, v31, v31, v4
    v_perm_b32 v37, v31, v31, v5
    v_perm_b32 v38, v31, v31, v6
    v_perm_b32 v39, v31, v31, v7
    v_mfma_f32_16x16x32_bf16 v[12:15], v[32:35], v[96:99], v[12:15]
    s_nop 0
    v_mfma_f32_16x16x32_bf16 v[16:19], v[36:39], v[96:99], v[16:19]
    v_mov_b32_dpp v30, v50 row_newbcast:1 row_mask:0xf bank_mask:0xf
    v_mov_b32_dpp v31, v51 row_newbcast:1 row_mask:0xf bank_mask:0xf
    v_perm_b32 v32, v30, v30, v4
    v_perm_b32 v33, v30, v30, v5
    v_perm_b32 v34, v30, v30, v6
    v_perm_b32 v35, v30, v30, v7
    v_perm_b32 v36, v31, v31, v4
    v_perm_b32 v37, v31, v31, v5
    v_perm_b32 v38, v31, v31, v6
    v_perm_b32 v39, v31, v31, v7
    v_mfma_f32_16x16x32_bf16 v[12:15], v[32:35], v[100:103], v[12:15]
    s_nop 0
    v_mfma_f32_16x16x32_bf16 v[16:19], v[36:39], v[100:103], v[16:19]
    s_lshl_b32 s14, s3, 11
    v_lshlrev_b32 v40, 4, v1
    v_add_u32 v40, s14, v40
    s_nop 2
    ds_write_b128 v40, v[12:15]
    s_nop 0
    ds_write_b128 v40, v[16:19] offset:1024
    s_waitcnt lgkmcnt(0)
    s_barrier
    ds_read_b64 v[18:19], v54 offset:0
    ds_read_b64 v[20:21], v54 offset:2048
    ds_read_b64 v[22:23], v54 offset:4096
    ds_read_b64 v[24:25], v54 offset:6144
    s_waitcnt lgkmcnt(0)
    v_add_f32 v18, v18, v20
    v_add_f32 v22, v22, v24
    v_add_f32 v19, v19, v21
    v_add_f32 v23, v23, v25
    v_add_f32 v26, v18, v22
    v_add_f32 v27, v19, v23
    s_lshl_b32 s14, s5, 2
    s_lshr_b32 s15, s6, 2
    s_add_u32 s14, s14, s15
    s_lshl_b32 s14, s14, 13
    s_lshl_b32 s15, s3, 11
    s_add_u32 s14, s14, s15
    s_and_b32 s15, s6, 3
    s_lshl_b32 s15, s15, 9
    s_add_u32 s14, s14, s15
    s_add_u32 s14, s14, 1048576
    v_lshl_add_u32 v40, v1, 3, s14
    buffer_store_dwordx2 v[26:27], v40, s[60:63], 0 offen sc1
    s_and_b32 s14, s6, 3
    s_lshl_b32 s14, s14, 6
    s_lshl_b32 s15, s5, 2
    s_add_u32 s14, s14, s15
    s_lshr_b32 s15, s6, 2
    s_add_u32 s14, s14, s15
    s_lshl_b32 s14, s14, 3
    s_add_u32 s14, s14, 598016
    v_mov_b32 v41, s14
    s_waitcnt vmcnt(0)
    s_barrier
    s_cmp_lg_u32 s3, 0
    s_cbranch_scc1 L_fin
    s_mov_b64 exec, 1
    buffer_store_dwordx2 v[28:29], v41, s[60:63], 0 offen sc1
    s_mov_b64 exec, -1
L_fin:
L_end:
    s_endpgm
.section .rodata,"a"
.p2align 6
.amdhsa_kernel gated_mix__mha_block_cached__geglu_ffn__decode_kernel
  .amdhsa_next_free_vgpr 256
  .amdhsa_next_free_sgpr 96
  .amdhsa_accum_offset 256
  .amdhsa_group_segment_fixed_size 0
  .amdhsa_kernarg_size 104
  .amdhsa_user_sgpr_count 2
  .amdhsa_user_sgpr_kernarg_segment_ptr 1
  .amdhsa_system_sgpr_workgroup_id_x 1
  .amdhsa_float_denorm_mode_32 3
.end_amdhsa_kernel
```
